```python
import torch

def _softmax(x, axis=-1):
    return torch.softmax(x, dim=axis)

def _gelu(x):
    return torch.nn.functional.gelu(x, approximate='tanh')

def _silu(x):
    return torch.nn.functional.silu(x)

def _sigmoid(x):
    return torch.sigmoid(x)

def _layernorm(x, axis=-1, eps=1e-05):
    m = x.mean(dim=axis, keepdim=True)
    v = x.var(dim=axis, keepdim=True, unbiased=False)
    return (x - m) / torch.sqrt(v + eps)

def _scatter_add(tgt, idx, src, axis=0):
    return tgt.clone().index_add_(axis, idx, src)

def _segment_sum(src, seg, n):
    out = torch.zeros((n,) + src.shape[1:], dtype=src.dtype)
    return out.index_add_(0, seg, src)

def _pad(x, pw):
    flat = tuple((v for pair in reversed(pw) for v in pair))
    return torch.nn.functional.pad(x, flat)
kernel_name = 'standalone__varlen_attn_packed__ragged'

def setup_inputs():

    _w = lambda a: (lambda t: t.to(torch.bfloat16) if t.is_floating_point() else t)(torch.as_tensor(a))
    cu = torch.tensor([0, 205, 520, 906, 1211, 1583, 1912, 2114, 2429, 2893, 2977, 3099, 3593, 3692, 4133, 4346, 4464], dtype=torch.int64)
    T, H, D = (int(cu[-1]), 16, 128)
    return {'q': _w((lambda *s: torch.randn(*s, dtype=torch.bfloat16) * 0.8)(T, H, D)), 'k': _w((lambda *s: torch.randn(*s, dtype=torch.bfloat16) * 0.8)(T, H, D)), 'v': _w((lambda *s: torch.randn(*s, dtype=torch.bfloat16) * 0.05)(T, H, D)), 'cu': _w(cu)}

def reference(q, k, v, cu):
    T, H, D = q.shape
    out = torch.zeros_like(q)
    scale = D ** (-0.5)
    outs = []
    for i in range(len(cu) - 1):
        s, e = (int(cu[i]), int(cu[i + 1]))
        qi, ki, vi = (q[s:e].clone(), k[s:e].clone(), v[s:e].clone())
        p = _softmax(torch.einsum('qhd,khd->hqk', qi, ki) * scale, axis=-1)
        outs.append(torch.einsum('hqk,khd->qhd', p, vi))
    return torch.concatenate(outs, axis=0)
```

```asm
; @launch grid=(256,1,1) block=(768,1,1) lds=160512
.amdgcn_target "amdgcn-amd-amdhsa--gfx950"
.text
.globl standalone__varlen_attn_packed__ragged_kernel
.p2align 8
.type standalone__varlen_attn_packed__ragged_kernel,@function
standalone__varlen_attn_packed__ragged_kernel:
    s_cmp_ge_u32 s2, 256
    s_cbranch_scc1 L_end
    s_load_dwordx4 s[4:7], s[0:1], 0
    v_readfirstlane_b32 s32, v0
    s_getpc_b64 s[44:45]
L_pc:
    s_lshr_b32 s3, s2, 4

    s_mulk_i32 s3, 384
    s_add_u32 s44, s44, L_tab-L_pc
    s_addc_u32 s45, s45, 0
    s_lshr_b32 s38, s32, 1
    s_add_u32 s3, s3, s38
    s_load_dwordx8 s[24:31], s[44:45], s3
    s_load_dwordx2 s[8:9], s[0:1], 16
    s_load_dwordx2 s[10:11], s[0:1], 32
    s_and_b32 s33, s2, 7
    s_lshl_b32 s33, s33, 9
    s_and_b32 s38, s2, 8
    s_lshl_b32 s38, s38, 5
    s_add_u32 s33, s33, s38
    s_cmp_eq_u32 s32, 0
    v_and_b32 v136, 63, v0
    v_lshrrev_b32 v137, 4, v136
    v_and_b32 v138, 15, v136
    v_lshlrev_b32 v144, 4, v138
    v_lshl_add_u32 v144, v137, 15, v144
    v_and_b32 v139, 32, v136
    v_lshlrev_b32 v139, 9, v139
    v_and_b32 v140, 8, v136
    v_lshl_add_u32 v139, v140, 12, v139
    v_and_b32 v140, 16, v136
    v_lshl_add_u32 v139, v140, 3, v139
    v_and_b32 v140, 7, v136
    v_lshl_add_u32 v139, v140, 4, v139
    s_cselect_b64 vcc, -1, 0
    s_mov_b32 s37, 57344
    s_cselect_b32 s37, 8192, s37
    v_cndmask_b32 v139, v139, v144, vcc
    v_add_u32 v140, 3040, v139
    s_mov_b32 s15, 0x20000

    s_waitcnt lgkmcnt(0)
    s_cselect_b64 s[12:13], s[6:7], s[4:5]
    s_add_u32 s24, s24, s33
    s_add_u32 s12, s12, s24
    s_addc_u32 s13, s13, 0
    s_mov_b32 s14, s25
    s_and_b32 m0, s27, 0x3ffff
    s_mov_b32 s36, s26
    s_and_b32 s38, s28, 31
    s_cbranch_scc1 L_late
    s_bitcmp1_b32 s28, 6
    s_cbranch_scc1 L_late
    buffer_load_dwordx4 v139, s[12:15], s36 offen nt lds
    buffer_load_dwordx4 v140, s[12:15], s36 offen offset:1056 nt lds
    s_add_u32 m0, m0, 2112
    s_add_u32 s36, s36, 8192
    buffer_load_dwordx4 v139, s[12:15], s36 offen nt lds
    buffer_load_dwordx4 v140, s[12:15], s36 offen offset:1056 nt lds
    s_add_u32 m0, m0, 2112
    s_add_u32 s36, s36, s37
    s_cbranch_vccz L_late
    s_bitcmp1_b32 s28, 31
    s_cbranch_scc0 L_k2
    s_waitcnt vmcnt(0)
    s_barrier
L_k2:
    buffer_load_dwordx4 v139, s[12:15], s36 offen nt lds
    buffer_load_dwordx4 v140, s[12:15], s36 offen offset:1056 nt lds
    s_add_u32 m0, m0, 2112
    s_add_u32 s36, s36, 8192
    buffer_load_dwordx4 v139, s[12:15], s36 offen nt lds
    buffer_load_dwordx4 v140, s[12:15], s36 offen offset:1056 nt lds
    s_branch L_loader
L_late:
    s_cmp_ge_u32 s38, 30
    s_cbranch_scc1 L_other
    v_and_b32 v141, 7, v136
    v_mul_u32_u24 v141, 1056, v141
    v_and_b32 v142, 8, v136
    v_lshl_add_u32 v141, v142, 5, v141
    v_lshl_add_u32 v141, v137, 4, v141
    v_and_b32 v143, 3, v136
    v_mul_u32_u24 v143, 1056, v143
    v_lshl_add_u32 v143, v142, 4, v143
    v_and_b32 v142, 4, v136
    v_lshl_add_u32 v143, v142, 7, v143
    v_lshl_add_u32 v143, v137, 4, v143
    v_add_u32 v7, s27, v143
    s_bfe_u32 s39, s29, 0x30012
    s_mulk_i32 s39, 16896
    v_add_u32 v0, s39, v141
    s_add_u32 s39, s39, 8448
    v_bfe_u32 v141, v136, 2, 3
    v_mul_u32_u24 v141, 1056, v141
    v_and_b32 v142, 32, v136
    v_lshl_add_u32 v141, v142, 3, v141
    v_and_b32 v142, 3, v136
    v_lshl_add_u32 v141, v142, 3, v141
    v_add_u32 v2, s39, v141
    s_and_b32 s29, s29, 0x3ffff
    v_mul_u32_u24 v141, 272, v138
    v_lshl_add_u32 v141, v137, 3, v141
    v_and_b32 v142, 8, v136
    v_xor_b32 v141, v141, v142
    v_add_u32 v1, s29, v141
    v_lshlrev_b32 v142, 4, v138
    v_lshl_add_u32 v6, v137, 12, v142
    v_mul_u32_u24 v141, 272, v137
    v_add3_u32 v3, v141, v142, s29
    s_bfe_u32 s38, s28, 0x60012
    v_lshlrev_b32 v141, 2, v137
    v_sub_u32 v141, s38, v141
    v_mov_b32 v142, 0xff800000
    v_mov_b32 v4, 0
    v_mov_b32 v5, 0
    s_mov_b32 s41, 16896
    s_mov_b32 s42, -84480
    s_lshr_b32 s43, s28, 29
    s_mov_b32 s16, 0x3e0293ee
    s_mov_b32 s17, 0x3e0293ee
    v_cmp_ge_i32 s[44:45], 0, v141
    v_cmp_ge_i32 s[46:47], 1, v141
    v_cmp_ge_i32 s[48:49], 2, v141
    v_cmp_ge_i32 s[50:51], 3, v141
    v_cndmask_b32 v104, 0, v142, s[44:45]
    v_cndmask_b32 v105, 0, v142, s[46:47]
    v_cndmask_b32 v106, 0, v142, s[48:49]
    v_cndmask_b32 v107, 0, v142, s[50:51]
    v_cndmask_b32 v108, 0, v142, s[44:45]
    v_cndmask_b32 v109, 0, v142, s[46:47]
    v_cndmask_b32 v110, 0, v142, s[48:49]
    v_cndmask_b32 v111, 0, v142, s[50:51]
    v_cmp_ge_i32 s[44:45], 16, v141
    v_cmp_ge_i32 s[46:47], 17, v141
    v_cmp_ge_i32 s[48:49], 18, v141
    v_cmp_ge_i32 s[50:51], 19, v141
    v_cndmask_b32 v112, 0, v142, s[44:45]
    v_cndmask_b32 v113, 0, v142, s[46:47]
    v_cndmask_b32 v114, 0, v142, s[48:49]
    v_cndmask_b32 v115, 0, v142, s[50:51]
    v_cndmask_b32 v116, 0, v142, s[44:45]
    v_cndmask_b32 v117, 0, v142, s[46:47]
    v_cndmask_b32 v118, 0, v142, s[48:49]
    v_cndmask_b32 v119, 0, v142, s[50:51]
    s_sub_u32 s38, s25, s26
    v_lshlrev_b32 v141, 12, v138
    v_add_u32 v143, 65536, v141
    v_cmp_lt_u32 s[44:45], s38, v141
    v_cmp_lt_u32 s[46:47], s38, v143
    v_mov_b32 v120, 0
    v_mov_b32 v121, 0
    v_mov_b32 v122, 0
    v_mov_b32 v123, 0
    s_nop 1
    v_mfma_f32_32x32x16_bf16 v[40:55], v[120:123], v[120:123], 0
    v_mfma_f32_32x32x16_bf16 v[56:71], v[120:123], v[120:123], 0
    v_mfma_f32_32x32x16_bf16 v[72:87], v[120:123], v[120:123], 0
    v_mfma_f32_32x32x16_bf16 v[88:103], v[120:123], v[120:123], 0
    v_cndmask_b32 v128, 0, v142, s[44:45]
    v_cndmask_b32 v132, 0, v142, s[46:47]
    s_bitcmp1_b32 s28, 13
    s_cselect_b32 s35, s42, s41
    s_and_b32 s38, s28, 31
    s_cbranch_scc1 L_late2
    s_bitcmp1_b32 s28, 6
    s_cbranch_scc0 L_q1
    s_barrier
    s_bitcmp1_b32 s28, 5
    s_cbranch_scc0 L_q0
    s_barrier
L_q0:
    buffer_load_dwordx4 v139, s[12:15], s36 offen nt lds
    buffer_load_dwordx4 v140, s[12:15], s36 offen offset:1056 nt lds
    s_add_u32 m0, m0, 2112
    s_add_u32 s36, s36, 8192
    buffer_load_dwordx4 v139, s[12:15], s36 offen nt lds
    buffer_load_dwordx4 v140, s[12:15], s36 offen offset:1056 nt lds
    s_add_u32 m0, m0, 2112
    s_add_u32 s36, s36, s37
L_q1:
    s_bitcmp1_b32 s28, 12
    s_cbranch_scc0 L_q2
    s_waitcnt vmcnt(0)
L_q2:
    buffer_load_dwordx4 v139, s[12:15], s36 offen nt lds
    buffer_load_dwordx4 v140, s[12:15], s36 offen offset:1056 nt lds
    s_add_u32 m0, m0, 2112
    s_add_u32 s36, s36, 8192
    buffer_load_dwordx4 v139, s[12:15], s36 offen nt lds
    buffer_load_dwordx4 v140, s[12:15], s36 offen offset:1056 nt lds
    s_barrier
    ds_read_b128 v[152:155], v0 offset:0
    ds_read_b128 v[156:159], v0 offset:64
    ds_read_b128 v[160:163], v0 offset:128
    ds_read_b128 v[164:167], v0 offset:192
    ds_read_b128 v[136:139], v0 offset:512
    ds_read_b128 v[140:143], v0 offset:576
    ds_read_b128 v[144:147], v0 offset:640
    ds_read_b128 v[148:151], v0 offset:704
    s_waitcnt vmcnt(4)
    ds_read_b128 v[8:11], v7 offset:0
    ds_read_b128 v[12:15], v7 offset:64
    ds_read_b128 v[16:19], v7 offset:256
    ds_read_b128 v[20:23], v7 offset:320
    s_waitcnt lgkmcnt(3)
    v_lshlrev_b32 v124, 16, v8
    v_and_b32 v125, 0xffff0000, v8
    v_lshlrev_b32 v126, 16, v9
    v_and_b32 v127, 0xffff0000, v9
    v_pk_mul_f32 v[124:125], v[124:125], s[16:17]
    v_pk_mul_f32 v[126:127], v[126:127], s[16:17]
    v_cvt_pk_bf16_f32 v8, v124, v125
    v_cvt_pk_bf16_f32 v9, v126, v127
    v_lshlrev_b32 v124, 16, v10
    v_and_b32 v125, 0xffff0000, v10
    v_lshlrev_b32 v126, 16, v11
    v_and_b32 v127, 0xffff0000, v11
    v_pk_mul_f32 v[124:125], v[124:125], s[16:17]
    v_pk_mul_f32 v[126:127], v[126:127], s[16:17]
    v_cvt_pk_bf16_f32 v10, v124, v125
    v_cvt_pk_bf16_f32 v11, v126, v127
    s_waitcnt lgkmcnt(2)
    v_lshlrev_b32 v124, 16, v12
    v_and_b32 v125, 0xffff0000, v12
    v_lshlrev_b32 v126, 16, v13
    v_and_b32 v127, 0xffff0000, v13
    v_pk_mul_f32 v[124:125], v[124:125], s[16:17]
    v_pk_mul_f32 v[126:127], v[126:127], s[16:17]
    v_cvt_pk_bf16_f32 v12, v124, v125
    v_cvt_pk_bf16_f32 v13, v126, v127
    v_lshlrev_b32 v124, 16, v14
    v_and_b32 v125, 0xffff0000, v14
    v_lshlrev_b32 v126, 16, v15
    v_and_b32 v127, 0xffff0000, v15
    v_pk_mul_f32 v[124:125], v[124:125], s[16:17]
    v_pk_mul_f32 v[126:127], v[126:127], s[16:17]
    v_cvt_pk_bf16_f32 v14, v124, v125
    v_cvt_pk_bf16_f32 v15, v126, v127
    s_waitcnt lgkmcnt(1)
    v_lshlrev_b32 v124, 16, v16
    v_and_b32 v125, 0xffff0000, v16
    v_lshlrev_b32 v126, 16, v17
    v_and_b32 v127, 0xffff0000, v17
    v_pk_mul_f32 v[124:125], v[124:125], s[16:17]
    v_pk_mul_f32 v[126:127], v[126:127], s[16:17]
    v_cvt_pk_bf16_f32 v16, v124, v125
    v_cvt_pk_bf16_f32 v17, v126, v127
    v_lshlrev_b32 v124, 16, v18
    v_and_b32 v125, 0xffff0000, v18
    v_lshlrev_b32 v126, 16, v19
    v_and_b32 v127, 0xffff0000, v19
    v_pk_mul_f32 v[124:125], v[124:125], s[16:17]
    v_pk_mul_f32 v[126:127], v[126:127], s[16:17]
    v_cvt_pk_bf16_f32 v18, v124, v125
    v_cvt_pk_bf16_f32 v19, v126, v127
    s_waitcnt lgkmcnt(0)
    v_lshlrev_b32 v124, 16, v20
    v_and_b32 v125, 0xffff0000, v20
    v_lshlrev_b32 v126, 16, v21
    v_and_b32 v127, 0xffff0000, v21
    v_pk_mul_f32 v[124:125], v[124:125], s[16:17]
    v_pk_mul_f32 v[126:127], v[126:127], s[16:17]
    v_cvt_pk_bf16_f32 v20, v124, v125
    v_cvt_pk_bf16_f32 v21, v126, v127
    v_lshlrev_b32 v124, 16, v22
    v_and_b32 v125, 0xffff0000, v22
    v_lshlrev_b32 v126, 16, v23
    v_and_b32 v127, 0xffff0000, v23
    v_pk_mul_f32 v[124:125], v[124:125], s[16:17]
    v_pk_mul_f32 v[126:127], v[126:127], s[16:17]
    v_cvt_pk_bf16_f32 v22, v124, v125
    v_cvt_pk_bf16_f32 v23, v126, v127
    s_nop 0
    v_mfma_f32_16x16x32_bf16 v[104:107], v[152:155], v[8:11], v[104:107]
    v_mfma_f32_16x16x32_bf16 v[112:115], v[136:139], v[8:11], v[112:115]
    v_mfma_f32_16x16x32_bf16 v[104:107], v[156:159], v[12:15], v[104:107]
    v_mfma_f32_16x16x32_bf16 v[112:115], v[140:143], v[12:15], v[112:115]
    v_mfma_f32_16x16x32_bf16 v[104:107], v[160:163], v[16:19], v[104:107]
    v_mfma_f32_16x16x32_bf16 v[112:115], v[144:147], v[16:19], v[112:115]
    v_mfma_f32_16x16x32_bf16 v[104:107], v[164:167], v[20:23], v[104:107]
    v_mfma_f32_16x16x32_bf16 v[112:115], v[148:151], v[20:23], v[112:115]
    s_nop 6
    v_max3_f32 v124, v104, v105, v106
    v_max3_f32 v124, v124, v107, v112
    v_max3_f32 v124, v124, v113, v114
    v_max_f32 v125, v124, v115
    v_max_f32 v124, v124, v115
    s_nop 1
    v_permlane32_swap_b32 v124, v125
    v_max_f32 v124, v124, v125
    v_max_f32 v125, v124, v125
    s_nop 1
    v_permlane16_swap_b32 v124, v125
    v_max_f32 v124, v124, v125
    v_sub_f32 v128, v128, v124
    v_add_f32 v104, v104, v128
    v_add_f32 v105, v105, v128
    v_add_f32 v106, v106, v128
    v_add_f32 v107, v107, v128
    v_exp_f32 v104, v104
    v_add_f32 v112, v112, v128
    v_exp_f32 v105, v105
    v_add_f32 v113, v113, v128
    v_exp_f32 v106, v106
    v_add_f32 v114, v114, v128
    v_exp_f32 v107, v107
    v_add_f32 v115, v115, v128
    v_exp_f32 v112, v112
    v_add_f32 v4, v4, v104
    v_exp_f32 v113, v113
    v_add_f32 v4, v4, v105
    v_exp_f32 v114, v114
    v_add_f32 v4, v4, v106
    v_exp_f32 v115, v115
    v_add_f32 v4, v4, v107
    v_cvt_pk_bf16_f32 v120, v104, v105
    v_cvt_pk_bf16_f32 v121, v106, v107
    v_add_f32 v4, v4, v112
    v_add_f32 v4, v4, v113
    v_add_f32 v4, v4, v114
    v_add_f32 v4, v4, v115
    v_cvt_pk_bf16_f32 v122, v112, v113
    v_cvt_pk_bf16_f32 v123, v114, v115
    s_setprio 3
    s_waitcnt vmcnt(0)
    ds_read_b128 v[24:27], v7 offset:4224
    ds_read_b128 v[28:31], v7 offset:4288
    ds_read_b128 v[32:35], v7 offset:4480
    ds_read_b128 v[36:39], v7 offset:4544
    s_waitcnt lgkmcnt(3)
    v_lshlrev_b32 v124, 16, v24
    v_and_b32 v125, 0xffff0000, v24
    v_lshlrev_b32 v126, 16, v25
    v_and_b32 v127, 0xffff0000, v25
    v_pk_mul_f32 v[124:125], v[124:125], s[16:17]
    v_pk_mul_f32 v[126:127], v[126:127], s[16:17]
    v_cvt_pk_bf16_f32 v24, v124, v125
    v_cvt_pk_bf16_f32 v25, v126, v127
    v_lshlrev_b32 v124, 16, v26
    v_and_b32 v125, 0xffff0000, v26
    v_lshlrev_b32 v126, 16, v27
    v_and_b32 v127, 0xffff0000, v27
    v_pk_mul_f32 v[124:125], v[124:125], s[16:17]
    v_pk_mul_f32 v[126:127], v[126:127], s[16:17]
    v_cvt_pk_bf16_f32 v26, v124, v125
    v_cvt_pk_bf16_f32 v27, v126, v127
    s_waitcnt lgkmcnt(2)
    v_lshlrev_b32 v124, 16, v28
    v_and_b32 v125, 0xffff0000, v28
    v_lshlrev_b32 v126, 16, v29
    v_and_b32 v127, 0xffff0000, v29
    v_pk_mul_f32 v[124:125], v[124:125], s[16:17]
    v_pk_mul_f32 v[126:127], v[126:127], s[16:17]
    v_cvt_pk_bf16_f32 v28, v124, v125
    v_cvt_pk_bf16_f32 v29, v126, v127
    v_lshlrev_b32 v124, 16, v30
    v_and_b32 v125, 0xffff0000, v30
    v_lshlrev_b32 v126, 16, v31
    v_and_b32 v127, 0xffff0000, v31
    v_pk_mul_f32 v[124:125], v[124:125], s[16:17]
    v_pk_mul_f32 v[126:127], v[126:127], s[16:17]
    v_cvt_pk_bf16_f32 v30, v124, v125
    v_cvt_pk_bf16_f32 v31, v126, v127
    s_waitcnt lgkmcnt(1)
    v_lshlrev_b32 v124, 16, v32
    v_and_b32 v125, 0xffff0000, v32
    v_lshlrev_b32 v126, 16, v33
    v_and_b32 v127, 0xffff0000, v33
    v_pk_mul_f32 v[124:125], v[124:125], s[16:17]
    v_pk_mul_f32 v[126:127], v[126:127], s[16:17]
    v_cvt_pk_bf16_f32 v32, v124, v125
    v_cvt_pk_bf16_f32 v33, v126, v127
    v_lshlrev_b32 v124, 16, v34
    v_and_b32 v125, 0xffff0000, v34
    v_lshlrev_b32 v126, 16, v35
    v_and_b32 v127, 0xffff0000, v35
    v_pk_mul_f32 v[124:125], v[124:125], s[16:17]
    v_pk_mul_f32 v[126:127], v[126:127], s[16:17]
    v_cvt_pk_bf16_f32 v34, v124, v125
    v_cvt_pk_bf16_f32 v35, v126, v127
    s_waitcnt lgkmcnt(0)
    v_lshlrev_b32 v124, 16, v36
    v_and_b32 v125, 0xffff0000, v36
    v_lshlrev_b32 v126, 16, v37
    v_and_b32 v127, 0xffff0000, v37
    v_pk_mul_f32 v[124:125], v[124:125], s[16:17]
    v_pk_mul_f32 v[126:127], v[126:127], s[16:17]
    v_cvt_pk_bf16_f32 v36, v124, v125
    v_cvt_pk_bf16_f32 v37, v126, v127
    v_lshlrev_b32 v124, 16, v38
    v_and_b32 v125, 0xffff0000, v38
    v_lshlrev_b32 v126, 16, v39
    v_and_b32 v127, 0xffff0000, v39
    v_pk_mul_f32 v[124:125], v[124:125], s[16:17]
    v_pk_mul_f32 v[126:127], v[126:127], s[16:17]
    v_cvt_pk_bf16_f32 v38, v124, v125
    v_cvt_pk_bf16_f32 v39, v126, v127
    s_nop 0
    v_mfma_f32_16x16x32_bf16 v[108:111], v[152:155], v[24:27], v[108:111]
    v_mfma_f32_16x16x32_bf16 v[116:119], v[136:139], v[24:27], v[116:119]
    v_mfma_f32_16x16x32_bf16 v[108:111], v[156:159], v[28:31], v[108:111]
    v_mfma_f32_16x16x32_bf16 v[116:119], v[140:143], v[28:31], v[116:119]
    v_mfma_f32_16x16x32_bf16 v[108:111], v[160:163], v[32:35], v[108:111]
    v_mfma_f32_16x16x32_bf16 v[116:119], v[144:147], v[32:35], v[116:119]
    v_mfma_f32_16x16x32_bf16 v[108:111], v[164:167], v[36:39], v[108:111]
    v_mfma_f32_16x16x32_bf16 v[116:119], v[148:151], v[36:39], v[116:119]
    s_nop 6
    v_max3_f32 v124, v108, v109, v110
    v_max3_f32 v124, v124, v111, v116
    v_max3_f32 v124, v124, v117, v118
    v_max_f32 v125, v124, v119
    v_max_f32 v124, v124, v119
    s_nop 1
    v_permlane32_swap_b32 v124, v125
    v_max_f32 v124, v124, v125
    v_max_f32 v125, v124, v125
    s_nop 1
    v_permlane16_swap_b32 v124, v125
    v_max_f32 v124, v124, v125
    v_sub_f32 v132, v132, v124
L_go:
    s_bitcmp1_b32 s28, 15
    v_add_f32 v108, v108, v132
    v_add_f32 v109, v109, v132
    v_add_f32 v110, v110, v132
    v_add_f32 v111, v111, v132
    v_exp_f32 v108, v108
    v_add_f32 v116, v116, v132
    v_exp_f32 v109, v109
    v_add_f32 v117, v117, v132
    v_exp_f32 v110, v110
    v_add_f32 v118, v118, v132
    v_exp_f32 v111, v111
    v_add_f32 v119, v119, v132
    v_add_u32 v0, s35, v0
    v_add_u32 v2, s35, v2
    v_mov_b32 v129, v128
    v_mov_b32 v130, v128
    v_mov_b32 v131, v128
    v_mov_b32 v133, v132
    v_mov_b32 v134, v132
    v_mov_b32 v135, v132
    s_setprio 1
    s_cbranch_scc1 L_sb1
    s_barrier
L_sb1:
    ds_read_b128 v[152:155], v0 offset:0
    ds_read_b128 v[156:159], v0 offset:64
    ds_read_b128 v[160:163], v0 offset:128
    ds_read_b128 v[164:167], v0 offset:192
    ds_read_b128 v[136:139], v0 offset:512
    ds_read_b128 v[140:143], v0 offset:576
    ds_read_b128 v[144:147], v0 offset:640
    ds_read_b128 v[148:151], v0 offset:704
    v_exp_f32 v116, v116
    v_add_f32 v5, v5, v108
    v_exp_f32 v117, v117
    v_add_f32 v5, v5, v109
    v_exp_f32 v118, v118
    v_add_f32 v5, v5, v110
    v_exp_f32 v119, v119
    v_add_f32 v5, v5, v111
    v_cvt_pk_bf16_f32 v124, v108, v109
    v_cvt_pk_bf16_f32 v125, v110, v111
    s_waitcnt lgkmcnt(6)
    v_mfma_f32_16x16x32_bf16 v[104:107], v[152:155], v[8:11], v[128:131]
    v_add_f32 v5, v5, v116
    v_add_f32 v5, v5, v117
    v_mfma_f32_16x16x32_bf16 v[108:111], v[152:155], v[24:27], v[132:135]
    v_cvt_pk_bf16_f32 v126, v116, v117
    v_mfma_f32_16x16x32_bf16 v[104:107], v[156:159], v[12:15], v[104:107]
    s_waitcnt lgkmcnt(4)
    v_add_f32 v5, v5, v118
    v_add_f32 v5, v5, v119
    v_mfma_f32_16x16x32_bf16 v[108:111], v[156:159], v[28:31], v[108:111]
    ds_read_b64_tr_b16 v[152:153], v2 offset:0
    ds_read_b64_tr_b16 v[154:155], v2 offset:512
    v_cvt_pk_bf16_f32 v127, v118, v119
    v_mfma_f32_16x16x32_bf16 v[104:107], v[160:163], v[16:19], v[104:107]
    v_mfma_f32_16x16x32_bf16 v[108:111], v[160:163], v[32:35], v[108:111]
    ds_read_b64_tr_b16 v[156:157], v2 offset:32
    ds_read_b64_tr_b16 v[158:159], v2 offset:544
    v_mfma_f32_16x16x32_bf16 v[104:107], v[164:167], v[20:23], v[104:107]
    v_mfma_f32_16x16x32_bf16 v[108:111], v[164:167], v[36:39], v[108:111]
    s_waitcnt lgkmcnt(4)
    ds_read_b64_tr_b16 v[160:161], v2 offset:64
    ds_read_b64_tr_b16 v[162:163], v2 offset:576
    s_nop 3
    s_bitcmp1_b32 s30, 3
    s_cbranch_scc0 L_loop
L_warm:
    v_mfma_f32_16x16x32_bf16 v[112:115], v[136:139], v[8:11], v[128:131]
    s_bitcmp1_b32 s30, 1
    v_mfma_f32_16x16x32_bf16 v[116:119], v[136:139], v[24:27], v[132:135]
    s_cselect_b32 s35, s42, s41
    ds_read_b64_tr_b16 v[164:165], v2 offset:96
    ds_read_b64_tr_b16 v[166:167], v2 offset:608
    v_add_u32 v0, s35, v0
    v_mfma_f32_16x16x32_bf16 v[112:115], v[140:143], v[12:15], v[112:115]
    v_mfma_f32_16x16x32_bf16 v[116:119], v[140:143], v[28:31], v[116:119]
    ds_read_b64_tr_b16 v[136:137], v2 offset:128
    ds_read_b64_tr_b16 v[138:139], v2 offset:640
    v_mfma_f32_16x16x32_bf16 v[112:115], v[144:147], v[16:19], v[112:115]
    v_mfma_f32_16x16x32_bf16 v[116:119], v[144:147], v[32:35], v[116:119]
    ds_read_b64_tr_b16 v[140:141], v2 offset:160
    ds_read_b64_tr_b16 v[142:143], v2 offset:672
    v_mfma_f32_16x16x32_bf16 v[112:115], v[148:151], v[20:23], v[112:115]
    v_mfma_f32_16x16x32_bf16 v[116:119], v[148:151], v[36:39], v[116:119]
    s_waitcnt lgkmcnt(2)
    ds_read_b64_tr_b16 v[144:145], v2 offset:192
    ds_read_b64_tr_b16 v[146:147], v2 offset:704
    v_mfma_f32_16x16x32_bf16 v[40:43], v[152:155], v[120:123], v[40:43]
    v_mfma_f32_16x16x32_bf16 v[72:75], v[152:155], v[124:127], v[72:75]
    s_bitcmp1_b32 s30, 0
    ds_read_b64_tr_b16 v[148:149], v2 offset:224
    ds_read_b64_tr_b16 v[150:151], v2 offset:736
    v_mfma_f32_16x16x32_bf16 v[44:47], v[156:159], v[120:123], v[44:47]
    s_cbranch_scc1 L_lag3
    s_barrier
L_sb3:
    v_add_u32 v2, s35, v2
    v_exp_f32 v104, v104
    v_exp_f32 v105, v105
    v_exp_f32 v106, v106
    v_exp_f32 v107, v107
    v_exp_f32 v108, v108
    v_exp_f32 v109, v109
    v_exp_f32 v110, v110
    v_exp_f32 v111, v111
    v_add_f32 v4, v4, v104
    v_add_f32 v4, v4, v105
    v_add_f32 v4, v4, v106
    v_add_f32 v4, v4, v107
    v_add_f32 v5, v5, v108
    v_add_f32 v5, v5, v109
    v_add_f32 v5, v5, v110
    v_add_f32 v5, v5, v111
    v_mfma_f32_16x16x32_bf16 v[76:79], v[156:159], v[124:127], v[76:79]
    ds_read_b128 v[152:155], v0 offset:0
    v_mfma_f32_16x16x32_bf16 v[48:51], v[160:163], v[120:123], v[48:51]
    v_mfma_f32_16x16x32_bf16 v[80:83], v[160:163], v[124:127], v[80:83]
    ds_read_b128 v[156:159], v0 offset:64
    s_waitcnt lgkmcnt(6)
    v_mfma_f32_16x16x32_bf16 v[52:55], v[164:167], v[120:123], v[52:55]
    v_mfma_f32_16x16x32_bf16 v[84:87], v[164:167], v[124:127], v[84:87]
    v_mfma_f32_16x16x32_bf16 v[56:59], v[136:139], v[120:123], v[56:59]
    v_mfma_f32_16x16x32_bf16 v[88:91], v[136:139], v[124:127], v[88:91]
    ds_read_b128 v[160:163], v0 offset:128
    ds_read_b128 v[164:167], v0 offset:192
    v_mfma_f32_16x16x32_bf16 v[60:63], v[140:143], v[120:123], v[60:63]
    v_mfma_f32_16x16x32_bf16 v[92:95], v[140:143], v[124:127], v[92:95]
    s_waitcnt lgkmcnt(3)
    ds_read_b128 v[136:139], v0 offset:512
    v_mfma_f32_16x16x32_bf16 v[64:67], v[144:147], v[120:123], v[64:67]
    v_mfma_f32_16x16x32_bf16 v[96:99], v[144:147], v[124:127], v[96:99]
    ds_read_b128 v[140:143], v0 offset:576
    v_mfma_f32_16x16x32_bf16 v[68:71], v[148:151], v[120:123], v[68:71]
    v_mfma_f32_16x16x32_bf16 v[100:103], v[148:151], v[124:127], v[100:103]
    ds_read_b128 v[144:147], v0 offset:640
    v_cvt_pk_bf16_f32 v120, v104, v105
    v_cvt_pk_bf16_f32 v121, v106, v107
    v_mfma_f32_16x16x32_bf16 v[104:107], v[152:155], v[8:11], v[128:131]
    s_waitcnt lgkmcnt(3)
    v_cvt_pk_bf16_f32 v124, v108, v109
    v_cvt_pk_bf16_f32 v125, v110, v111
    v_mfma_f32_16x16x32_bf16 v[108:111], v[152:155], v[24:27], v[132:135]
    ds_read_b128 v[148:151], v0 offset:704
    v_exp_f32 v112, v112
    v_exp_f32 v113, v113
    v_exp_f32 v114, v114
    v_exp_f32 v115, v115
    v_exp_f32 v116, v116
    v_exp_f32 v117, v117
    v_exp_f32 v118, v118
    v_exp_f32 v119, v119
    v_add_f32 v4, v4, v112
    v_add_f32 v4, v4, v113
    v_add_f32 v4, v4, v114
    v_add_f32 v4, v4, v115
    v_add_f32 v5, v5, v116
    v_add_f32 v5, v5, v117
    v_add_f32 v5, v5, v118
    v_add_f32 v5, v5, v119
    v_mfma_f32_16x16x32_bf16 v[104:107], v[156:159], v[12:15], v[104:107]
    v_mfma_f32_16x16x32_bf16 v[108:111], v[156:159], v[28:31], v[108:111]
    ds_read_b64_tr_b16 v[152:153], v2 offset:0
    ds_read_b64_tr_b16 v[154:155], v2 offset:512
    v_cvt_pk_bf16_f32 v122, v112, v113
    v_cvt_pk_bf16_f32 v123, v114, v115
    v_mfma_f32_16x16x32_bf16 v[104:107], v[160:163], v[16:19], v[104:107]
    v_mfma_f32_16x16x32_bf16 v[108:111], v[160:163], v[32:35], v[108:111]
    ds_read_b64_tr_b16 v[156:157], v2 offset:32
    ds_read_b64_tr_b16 v[158:159], v2 offset:544
    v_cvt_pk_bf16_f32 v126, v116, v117
    v_mfma_f32_16x16x32_bf16 v[104:107], v[164:167], v[20:23], v[104:107]
    v_mfma_f32_16x16x32_bf16 v[108:111], v[164:167], v[36:39], v[108:111]
    s_lshr_b64 s[30:31], s[30:31], 4
    ds_read_b64_tr_b16 v[160:161], v2 offset:64
    ds_read_b64_tr_b16 v[162:163], v2 offset:576
    s_waitcnt lgkmcnt(6)
    v_cvt_pk_bf16_f32 v127, v118, v119
    s_bitcmp1_b32 s30, 3
    s_cbranch_scc1 L_warm
    .p2align 6
L_loop:
    v_mfma_f32_16x16x32_bf16 v[112:115], v[136:139], v[8:11], v[128:131]
    s_bitcmp1_b32 s30, 1
    v_exp_f32 v104, v104
    v_mfma_f32_16x16x32_bf16 v[116:119], v[136:139], v[24:27], v[132:135]
    s_cselect_b32 s35, s42, s41
    ds_read_b64_tr_b16 v[164:165], v2 offset:96
    ds_read_b64_tr_b16 v[166:167], v2 offset:608
    v_add_u32 v0, s35, v0
    v_add_f32 v4, v4, v104
    v_mfma_f32_16x16x32_bf16 v[112:115], v[140:143], v[12:15], v[112:115]
    v_exp_f32 v106, v106
    v_mfma_f32_16x16x32_bf16 v[116:119], v[140:143], v[28:31], v[116:119]
    s_setprio 0
    ds_read_b64_tr_b16 v[136:137], v2 offset:128
    ds_read_b64_tr_b16 v[138:139], v2 offset:640
    v_mfma_f32_16x16x32_bf16 v[112:115], v[144:147], v[16:19], v[112:115]
    v_exp_f32 v105, v105
    v_mfma_f32_16x16x32_bf16 v[116:119], v[144:147], v[32:35], v[116:119]
    ds_read_b64_tr_b16 v[140:141], v2 offset:160
    ds_read_b64_tr_b16 v[142:143], v2 offset:672
    v_add_f32 v4, v4, v106
    v_add_f32 v4, v4, v105
    v_mfma_f32_16x16x32_bf16 v[112:115], v[148:151], v[20:23], v[112:115]
    v_exp_f32 v107, v107
    v_mfma_f32_16x16x32_bf16 v[116:119], v[148:151], v[36:39], v[116:119]
    s_waitcnt lgkmcnt(2)
    ds_read_b64_tr_b16 v[144:145], v2 offset:192
    ds_read_b64_tr_b16 v[146:147], v2 offset:704
    v_add_f32 v4, v4, v107
    v_mfma_f32_16x16x32_bf16 v[40:43], v[152:155], v[120:123], v[40:43]
    s_setprio 3
    v_exp_f32 v108, v108
    v_mfma_f32_16x16x32_bf16 v[72:75], v[152:155], v[124:127], v[72:75]
    s_bitcmp1_b32 s30, 0
    ds_read_b64_tr_b16 v[148:149], v2 offset:224
    ds_read_b64_tr_b16 v[150:151], v2 offset:736
    v_add_f32 v5, v5, v108
    v_mfma_f32_16x16x32_bf16 v[44:47], v[156:159], v[120:123], v[44:47]
    s_cbranch_scc1 L_lag2
    s_barrier
L_sb2:
    v_add_u32 v2, s35, v2
    v_mfma_f32_16x16x32_bf16 v[76:79], v[156:159], v[124:127], v[76:79]
    ds_read_b128 v[152:155], v0 offset:0
    v_exp_f32 v109, v109
    v_mfma_f32_16x16x32_bf16 v[48:51], v[160:163], v[120:123], v[48:51]
    v_exp_f32 v110, v110
    v_mfma_f32_16x16x32_bf16 v[80:83], v[160:163], v[124:127], v[80:83]
    ds_read_b128 v[156:159], v0 offset:64
    s_waitcnt lgkmcnt(6)
    v_add_f32 v5, v5, v109
    v_add_f32 v5, v5, v110
    v_mfma_f32_16x16x32_bf16 v[52:55], v[164:167], v[120:123], v[52:55]
    v_exp_f32 v112, v112
    v_mfma_f32_16x16x32_bf16 v[84:87], v[164:167], v[124:127], v[84:87]
    v_exp_f32 v113, v113
    v_mfma_f32_16x16x32_bf16 v[56:59], v[136:139], v[120:123], v[56:59]
    v_exp_f32 v111, v111
    v_mfma_f32_16x16x32_bf16 v[88:91], v[136:139], v[124:127], v[88:91]
    ds_read_b128 v[160:163], v0 offset:128
    ds_read_b128 v[164:167], v0 offset:192
    v_add_f32 v5, v5, v111
    v_add_f32 v4, v4, v112
    v_mfma_f32_16x16x32_bf16 v[60:63], v[140:143], v[120:123], v[60:63]
    s_setprio 2
    v_exp_f32 v114, v114
    v_mfma_f32_16x16x32_bf16 v[92:95], v[140:143], v[124:127], v[92:95]
    s_waitcnt lgkmcnt(3)
    ds_read_b128 v[136:139], v0 offset:512
    v_add_f32 v4, v4, v114
    v_add_f32 v4, v4, v113
    v_mfma_f32_16x16x32_bf16 v[64:67], v[144:147], v[120:123], v[64:67]
    v_exp_f32 v115, v115
    v_mfma_f32_16x16x32_bf16 v[96:99], v[144:147], v[124:127], v[96:99]
    ds_read_b128 v[140:143], v0 offset:576
    v_mfma_f32_16x16x32_bf16 v[68:71], v[148:151], v[120:123], v[68:71]
    v_exp_f32 v116, v116
    v_mfma_f32_16x16x32_bf16 v[100:103], v[148:151], v[124:127], v[100:103]
    ds_read_b128 v[144:147], v0 offset:640
    v_cvt_pk_bf16_f32 v120, v104, v105
    v_cvt_pk_bf16_f32 v121, v106, v107
    v_add_f32 v4, v4, v115
    v_mfma_f32_16x16x32_bf16 v[104:107], v[152:155], v[8:11], v[128:131]
    s_waitcnt lgkmcnt(3)
    v_cvt_pk_bf16_f32 v124, v108, v109
    v_cvt_pk_bf16_f32 v125, v110, v111
    v_mfma_f32_16x16x32_bf16 v[108:111], v[152:155], v[24:27], v[132:135]
    s_setprio 1
    ds_read_b128 v[148:151], v0 offset:704
    v_exp_f32 v117, v117
    v_mfma_f32_16x16x32_bf16 v[104:107], v[156:159], v[12:15], v[104:107]
    v_exp_f32 v119, v119
    v_mfma_f32_16x16x32_bf16 v[108:111], v[156:159], v[28:31], v[108:111]
    ds_read_b64_tr_b16 v[152:153], v2 offset:0
    ds_read_b64_tr_b16 v[154:155], v2 offset:512
    v_cvt_pk_bf16_f32 v122, v112, v113
    v_add_f32 v5, v5, v116
    v_mfma_f32_16x16x32_bf16 v[104:107], v[160:163], v[16:19], v[104:107]
    v_exp_f32 v118, v118
    v_mfma_f32_16x16x32_bf16 v[108:111], v[160:163], v[32:35], v[108:111]
    ds_read_b64_tr_b16 v[156:157], v2 offset:32
    ds_read_b64_tr_b16 v[158:159], v2 offset:544
    v_cvt_pk_bf16_f32 v123, v114, v115
    v_cvt_pk_bf16_f32 v126, v116, v117
    v_mfma_f32_16x16x32_bf16 v[104:107], v[164:167], v[20:23], v[104:107]
    v_add_f32 v5, v5, v117
    v_add_f32 v5, v5, v118
    v_mfma_f32_16x16x32_bf16 v[108:111], v[164:167], v[36:39], v[108:111]
    s_lshr_b64 s[30:31], s[30:31], 4
    ds_read_b64_tr_b16 v[160:161], v2 offset:64
    ds_read_b64_tr_b16 v[162:163], v2 offset:576
    s_waitcnt lgkmcnt(6)
    v_cvt_pk_bf16_f32 v127, v118, v119
    v_add_f32 v5, v5, v119
    s_cbranch_scc1 L_loop
    v_mfma_f32_16x16x32_bf16 v[112:115], v[136:139], v[8:11], v[128:131]
    v_exp_f32 v104, v104
    v_mfma_f32_16x16x32_bf16 v[116:119], v[136:139], v[24:27], v[132:135]
    s_bitcmp1_b32 s28, 14
    s_cselect_b32 s35, s42, s41
    ds_read_b64_tr_b16 v[164:165], v2 offset:96
    ds_read_b64_tr_b16 v[166:167], v2 offset:608
    v_exp_f32 v105, v105
    v_mfma_f32_16x16x32_bf16 v[112:115], v[140:143], v[12:15], v[112:115]
    s_add_u32 s12, s10, s24
    v_exp_f32 v106, v106
    v_mfma_f32_16x16x32_bf16 v[116:119], v[140:143], v[28:31], v[116:119]
    ds_read_b64_tr_b16 v[136:137], v2 offset:128
    ds_read_b64_tr_b16 v[138:139], v2 offset:640
    v_exp_f32 v109, v109
    v_mfma_f32_16x16x32_bf16 v[112:115], v[144:147], v[16:19], v[112:115]
    v_exp_f32 v107, v107
    v_mfma_f32_16x16x32_bf16 v[116:119], v[144:147], v[32:35], v[116:119]
    s_waitcnt lgkmcnt(4)
    ds_read_b64_tr_b16 v[140:141], v2 offset:160
    ds_read_b64_tr_b16 v[142:143], v2 offset:672
    v_exp_f32 v108, v108
    v_mfma_f32_16x16x32_bf16 v[112:115], v[148:151], v[20:23], v[112:115]
    s_addc_u32 s13, s11, 0
    v_exp_f32 v111, v111
    v_mfma_f32_16x16x32_bf16 v[116:119], v[148:151], v[36:39], v[116:119]
    s_setprio 0
    ds_read_b64_tr_b16 v[144:145], v2 offset:192
    ds_read_b64_tr_b16 v[146:147], v2 offset:704
    v_exp_f32 v110, v110
    v_mfma_f32_16x16x32_bf16 v[40:43], v[152:155], v[120:123], v[40:43]
    v_cvt_pk_bf16_f32 v8, v104, v105
    v_cvt_pk_bf16_f32 v9, v106, v107
    v_mfma_f32_16x16x32_bf16 v[72:75], v[152:155], v[124:127], v[72:75]
    s_bitcmp1_b32 s28, 16
    ds_read_b64_tr_b16 v[148:149], v2 offset:224
    ds_read_b64_tr_b16 v[150:151], v2 offset:736
    v_add_u32 v2, s35, v2
    v_mfma_f32_16x16x32_bf16 v[44:47], v[156:159], v[120:123], v[44:47]
    s_cbranch_scc1 L_sb4
    s_barrier
L_sb4:
    v_mfma_f32_16x16x32_bf16 v[76:79], v[156:159], v[124:127], v[76:79]
    ds_read_b64_tr_b16 v[154:155], v2 offset:512
    ds_read_b64_tr_b16 v[152:153], v2 offset:0
    v_exp_f32 v112, v112
    v_mfma_f32_16x16x32_bf16 v[48:51], v[160:163], v[120:123], v[48:51]
    s_waitcnt lgkmcnt(6)
    v_exp_f32 v113, v113
    v_mfma_f32_16x16x32_bf16 v[80:83], v[160:163], v[124:127], v[80:83]
    s_add_u32 s16, s26, 16384
    ds_read_b64_tr_b16 v[156:157], v2 offset:32
    ds_read_b64_tr_b16 v[158:159], v2 offset:544
    v_exp_f32 v114, v114
    v_mfma_f32_16x16x32_bf16 v[52:55], v[164:167], v[120:123], v[52:55]
    v_exp_f32 v115, v115
    v_mfma_f32_16x16x32_bf16 v[84:87], v[164:167], v[124:127], v[84:87]
    s_add_u32 s17, s26, 32768
    s_add_u32 s18, s26, 49152
    ds_read_b64_tr_b16 v[160:161], v2 offset:64
    ds_read_b64_tr_b16 v[162:163], v2 offset:576
    v_exp_f32 v116, v116
    v_mfma_f32_16x16x32_bf16 v[56:59], v[136:139], v[120:123], v[56:59]
    s_add_u32 s19, s26, 65536
    v_exp_f32 v117, v117
    v_mfma_f32_16x16x32_bf16 v[88:91], v[136:139], v[124:127], v[88:91]
    s_waitcnt lgkmcnt(2)
    s_add_u32 s20, s26, 81920
    ds_read_b64_tr_b16 v[164:165], v2 offset:96
    ds_read_b64_tr_b16 v[166:167], v2 offset:608
    v_exp_f32 v118, v118
    v_mfma_f32_16x16x32_bf16 v[60:63], v[140:143], v[120:123], v[60:63]
    s_add_u32 s21, s26, 98304
    v_exp_f32 v119, v119
    v_cvt_pk_bf16_f32 v12, v108, v109
    v_mfma_f32_16x16x32_bf16 v[92:95], v[140:143], v[124:127], v[92:95]
    ds_read_b64_tr_b16 v[136:137], v2 offset:128
    ds_read_b64_tr_b16 v[138:139], v2 offset:640
    v_cvt_pk_bf16_f32 v10, v112, v113
    v_cvt_pk_bf16_f32 v15, v118, v119
    v_cvt_pk_bf16_f32 v11, v114, v115
    v_mfma_f32_16x16x32_bf16 v[64:67], v[144:147], v[120:123], v[64:67]
    s_add_u32 s22, s26, 114688
    v_mfma_f32_16x16x32_bf16 v[96:99], v[144:147], v[124:127], v[96:99]
    s_waitcnt lgkmcnt(2)
    ds_read_b64_tr_b16 v[140:141], v2 offset:160
    ds_read_b64_tr_b16 v[142:143], v2 offset:672
    v_cvt_pk_bf16_f32 v14, v116, v117
    v_mfma_f32_16x16x32_bf16 v[68:71], v[148:151], v[120:123], v[68:71]
    v_add_f32 v4, v4, v106
    v_add_f32 v4, v4, v107
    v_add_f32 v4, v4, v104
    v_add_f32 v4, v4, v105
    v_cvt_pk_bf16_f32 v13, v110, v111
    v_mfma_f32_16x16x32_bf16 v[100:103], v[148:151], v[124:127], v[100:103]
    ds_read_b64_tr_b16 v[144:145], v2 offset:192
    ds_read_b64_tr_b16 v[146:147], v2 offset:704
    v_add_f32 v5, v5, v109
    v_add_f32 v5, v5, v108
    v_mfma_f32_16x16x32_bf16 v[40:43], v[152:155], v[8:11], v[40:43]
    v_add_f32 v4, v4, v114
    v_add_f32 v4, v4, v115
    v_mfma_f32_16x16x32_bf16 v[44:47], v[156:159], v[8:11], v[44:47]
    ds_read_b64_tr_b16 v[148:149], v2 offset:224
    ds_read_b64_tr_b16 v[150:151], v2 offset:736
    v_add_f32 v5, v5, v116
    v_add_f32 v4, v4, v112
    v_add_f32 v4, v4, v113
    v_add_f32 v5, v5, v110
    v_add_f32 v5, v5, v117
    v_mfma_f32_16x16x32_bf16 v[48:51], v[160:163], v[8:11], v[48:51]
    v_add_f32 v5, v5, v111
    v_mfma_f32_16x16x32_bf16 v[52:55], v[164:167], v[8:11], v[52:55]
    s_waitcnt lgkmcnt(4)
    v_add_f32 v5, v5, v118
    v_add_f32 v5, v5, v119
    v_mfma_f32_16x16x32_bf16 v[56:59], v[136:139], v[8:11], v[56:59]
    s_nop 0
    v_permlane32_swap_b32 v4, v5
    v_add_f32 v130, v4, v5
    v_add_f32 v131, v4, v5
    v_mfma_f32_16x16x32_bf16 v[60:63], v[140:143], v[8:11], v[60:63]
    s_waitcnt lgkmcnt(0)
    v_permlane16_swap_b32 v130, v131
    v_add_f32 v4, v130, v131
    v_add_f32 v5, v130, v131
    v_mfma_f32_16x16x32_bf16 v[64:67], v[144:147], v[8:11], v[64:67]
    s_nop 0
    v_permlane32_swap_b32 v4, v5
    v_rcp_f32 v128, v4
    v_mfma_f32_16x16x32_bf16 v[68:71], v[148:151], v[8:11], v[68:71]
    v_rcp_f32 v132, v5
    v_mfma_f32_16x16x32_bf16 v[72:75], v[152:155], v[12:15], v[72:75]
    v_add_u32 v7, 2176, v3
    v_mul_f32 v44, v44, v128
    v_mul_f32 v45, v45, v128
    v_mul_f32 v46, v46, v128
    v_mul_f32 v47, v47, v128
    v_mul_f32 v40, v40, v128
    v_mul_f32 v41, v41, v128
    v_mul_f32 v42, v42, v128
    v_mul_f32 v43, v43, v128
    v_cvt_pk_bf16_f32 v18, v44, v45
    v_cvt_pk_bf16_f32 v19, v46, v47
    v_mfma_f32_16x16x32_bf16 v[76:79], v[156:159], v[12:15], v[76:79]
    v_cvt_pk_bf16_f32 v16, v40, v41
    v_cvt_pk_bf16_f32 v17, v42, v43
    v_add_f32 v131, v4, v5
    v_cmp_nge_f32 vcc, 0x4e800000, v131
    v_mfma_f32_16x16x32_bf16 v[80:83], v[160:163], v[12:15], v[80:83]
    ds_write2_b64 v1, v[16:17], v[18:19] offset0:0 offset1:4
    v_mul_f32 v48, v48, v128
    v_mul_f32 v49, v49, v128
    v_mul_f32 v50, v50, v128
    v_mul_f32 v51, v51, v128
    v_mul_f32 v52, v52, v128
    v_mul_f32 v53, v53, v128
    v_mul_f32 v54, v54, v128
    v_mul_f32 v55, v55, v128
    v_cvt_pk_bf16_f32 v20, v48, v49
    v_cvt_pk_bf16_f32 v21, v50, v51
    v_mfma_f32_16x16x32_bf16 v[84:87], v[164:167], v[12:15], v[84:87]
    v_cvt_pk_bf16_f32 v22, v52, v53
    v_cvt_pk_bf16_f32 v23, v54, v55
    v_mfma_f32_16x16x32_bf16 v[88:91], v[136:139], v[12:15], v[88:91]
    ds_write2_b64 v1, v[20:21], v[22:23] offset0:8 offset1:12
    v_mul_f32 v60, v60, v128
    v_mul_f32 v61, v61, v128
    v_mul_f32 v62, v62, v128
    v_mul_f32 v63, v63, v128
    v_mul_f32 v56, v56, v128
    v_mul_f32 v57, v57, v128
    v_mul_f32 v58, v58, v128
    v_mul_f32 v59, v59, v128
    v_mfma_f32_16x16x32_bf16 v[92:95], v[140:143], v[12:15], v[92:95]
    v_cvt_pk_bf16_f32 v16, v56, v57
    v_cvt_pk_bf16_f32 v17, v58, v59
    v_cvt_pk_bf16_f32 v18, v60, v61
    v_cvt_pk_bf16_f32 v19, v62, v63
    v_mfma_f32_16x16x32_bf16 v[96:99], v[144:147], v[12:15], v[96:99]
    ds_write2_b64 v1, v[16:17], v[18:19] offset0:16 offset1:20
    v_mul_f32 v64, v64, v128
    v_mul_f32 v65, v65, v128
    v_mul_f32 v66, v66, v128
    v_mul_f32 v67, v67, v128
    v_mul_f32 v68, v68, v128
    v_mul_f32 v69, v69, v128
    v_mul_f32 v70, v70, v128
    v_mul_f32 v71, v71, v128
    v_cvt_pk_bf16_f32 v20, v64, v65
    v_cvt_pk_bf16_f32 v21, v66, v67
    v_cvt_pk_bf16_f32 v22, v68, v69
    v_cvt_pk_bf16_f32 v23, v70, v71
    v_mfma_f32_16x16x32_bf16 v[100:103], v[148:151], v[12:15], v[100:103]
    ds_write2_b64 v1, v[20:21], v[22:23] offset0:24 offset1:28
    ds_read2_b64 v[36:39], v7 offset0:137 offset1:136
    ds_read_b128 v[24:27], v3 offset:0
    ds_read_b128 v[28:31], v3 offset:1088
    ds_read2_b64 v[32:35], v7 offset0:1 offset1:0
    v_mul_f32 v72, v72, v132
    v_mul_f32 v73, v73, v132
    v_mul_f32 v74, v74, v132
    v_mul_f32 v75, v75, v132
    v_pk_mul_f32 v[76:77], v[76:77], v[132:133] op_sel_hi:[1,0]
    v_pk_mul_f32 v[78:79], v[78:79], v[132:133] op_sel_hi:[1,0]
    v_cvt_pk_bf16_f32 v16, v72, v73
    v_cvt_pk_bf16_f32 v17, v74, v75
    v_mul_f32 v80, v80, v132
    v_mul_f32 v81, v81, v132
    v_mul_f32 v82, v82, v132
    v_mul_f32 v83, v83, v132
    v_mul_f32 v84, v84, v132
    v_mul_f32 v85, v85, v132
    v_mul_f32 v86, v86, v132
    v_mul_f32 v87, v87, v132
    v_cvt_pk_bf16_f32 v18, v76, v77
    v_cvt_pk_bf16_f32 v19, v78, v79
    v_cvt_pk_bf16_f32 v20, v80, v81
    v_cvt_pk_bf16_f32 v21, v82, v83
    v_cvt_pk_bf16_f32 v22, v84, v85
    v_cvt_pk_bf16_f32 v23, v86, v87
    s_waitcnt lgkmcnt(0)
    buffer_store_dwordx4 v[32:35], v6, s[12:15], s17 offen sc1
    ds_write2_b64 v1, v[16:17], v[18:19] offset0:0 offset1:4
    buffer_store_dwordx4 v[28:31], v6, s[12:15], s16 offen sc1
    ds_write2_b64 v1, v[20:21], v[22:23] offset0:8 offset1:12
    buffer_store_dwordx4 v[24:27], v6, s[12:15], s26 offen sc1
    buffer_store_dwordx4 v[36:39], v6, s[12:15], s18 offen sc1
    v_pk_mul_f32 v[88:89], v[88:89], v[132:133] op_sel_hi:[1,0]
    v_pk_mul_f32 v[90:91], v[90:91], v[132:133] op_sel_hi:[1,0]
    v_pk_mul_f32 v[92:93], v[92:93], v[132:133] op_sel_hi:[1,0]
    v_pk_mul_f32 v[94:95], v[94:95], v[132:133] op_sel_hi:[1,0]
    v_cvt_pk_bf16_f32 v16, v88, v89
    v_cvt_pk_bf16_f32 v17, v90, v91
    v_pk_mul_f32 v[96:97], v[96:97], v[132:133] op_sel_hi:[1,0]
    v_pk_mul_f32 v[98:99], v[98:99], v[132:133] op_sel_hi:[1,0]
    v_pk_mul_f32 v[100:101], v[100:101], v[132:133] op_sel_hi:[1,0]
    v_pk_mul_f32 v[102:103], v[102:103], v[132:133] op_sel_hi:[1,0]
    v_cvt_pk_bf16_f32 v20, v96, v97
    v_cvt_pk_bf16_f32 v21, v98, v99
    v_cvt_pk_bf16_f32 v22, v100, v101
    v_cvt_pk_bf16_f32 v23, v102, v103
    v_cvt_pk_bf16_f32 v18, v92, v93
    v_cvt_pk_bf16_f32 v19, v94, v95
    ds_write2_b64 v1, v[20:21], v[22:23] offset0:24 offset1:28
    ds_write2_b64 v1, v[16:17], v[18:19] offset0:16 offset1:20
    ds_read_b128 v[104:107], v3 offset:0
    ds_read_b128 v[108:111], v3 offset:1088
    ds_read2_b64 v[112:115], v7 offset0:1 offset1:0
    ds_read2_b64 v[116:119], v7 offset0:137 offset1:136
    s_waitcnt lgkmcnt(3)
    buffer_store_dwordx4 v[104:107], v6, s[12:15], s19 offen sc1
    s_waitcnt lgkmcnt(2)
    buffer_store_dwordx4 v[108:111], v6, s[12:15], s20 offen sc1
    s_waitcnt lgkmcnt(1)
    buffer_store_dwordx4 v[112:115], v6, s[12:15], s21 offen sc1
    s_waitcnt lgkmcnt(0)
    buffer_store_dwordx4 v[116:119], v6, s[12:15], s22 offen sc1
    s_cbranch_vccnz L_exact
L_rest:
    s_bfe_u32 s38, s28, 0x50018
    s_cmp_eq_u32 s38, 0
    s_cbranch_scc1 L_b5d
L_b5:
    s_barrier
    s_sub_u32 s38, s38, 1
    s_cmp_lg_u32 s38, 0
    s_cbranch_scc1 L_b5
L_b5d:
L_end:
    s_endpgm
L_other:
    s_cmp_eq_u32 s38, 30
    s_cbranch_scc1 L_loader
    s_endpgm
L_late2:
    s_cmp_eq_u32 s38, 0
    s_cbranch_scc1 L_b6d
L_b6:
    s_barrier
    s_sub_u32 s38, s38, 1
    s_cmp_lg_u32 s38, 0
    s_cbranch_scc1 L_b6
L_b6d:
    buffer_load_dwordx4 v139, s[12:15], s36 offen nt lds
    buffer_load_dwordx4 v140, s[12:15], s36 offen offset:1056 nt lds
    s_add_u32 m0, m0, 2112
    s_add_u32 s36, s36, 8192
    buffer_load_dwordx4 v139, s[12:15], s36 offen nt lds
    buffer_load_dwordx4 v140, s[12:15], s36 offen offset:1056 nt lds
    s_add_u32 m0, m0, 2112
    s_add_u32 s36, s36, s37
    buffer_load_dwordx4 v139, s[12:15], s36 offen nt lds
    buffer_load_dwordx4 v140, s[12:15], s36 offen offset:1056 nt lds
    s_add_u32 m0, m0, 2112
    s_add_u32 s36, s36, 8192
    buffer_load_dwordx4 v139, s[12:15], s36 offen nt lds
    buffer_load_dwordx4 v140, s[12:15], s36 offen offset:1056 nt lds
    s_bfe_u32 s38, s28, 0x20005
    s_cmp_eq_u32 s38, 0
    s_cbranch_scc1 L_b7d
L_b7:
    s_barrier
    s_sub_u32 s38, s38, 1
    s_cmp_lg_u32 s38, 0
    s_cbranch_scc1 L_b7
L_b7d:
    s_waitcnt vmcnt(0)
    ds_read_b128 v[8:11], v7 offset:0
    ds_read_b128 v[12:15], v7 offset:64
    ds_read_b128 v[16:19], v7 offset:256
    ds_read_b128 v[20:23], v7 offset:320
    ds_read_b128 v[24:27], v7 offset:4224
    ds_read_b128 v[28:31], v7 offset:4288
    ds_read_b128 v[32:35], v7 offset:4480
    ds_read_b128 v[36:39], v7 offset:4544
    s_waitcnt lgkmcnt(0)
    s_bfe_u32 s38, s28, 0x50007
    s_cmp_eq_u32 s38, 0
    s_cbranch_scc1 L_b8d
L_b8:
    s_barrier
    s_sub_u32 s38, s38, 1
    s_cmp_lg_u32 s38, 0
    s_cbranch_scc1 L_b8
L_b8d:
    ds_read_b128 v[152:155], v0 offset:0
    ds_read_b128 v[156:159], v0 offset:64
    ds_read_b128 v[160:163], v0 offset:128
    ds_read_b128 v[164:167], v0 offset:192
    ds_read_b128 v[136:139], v0 offset:512
    ds_read_b128 v[140:143], v0 offset:576
    ds_read_b128 v[144:147], v0 offset:640
    ds_read_b128 v[148:151], v0 offset:704
    v_lshlrev_b32 v124, 16, v8
    v_and_b32 v125, 0xffff0000, v8
    v_lshlrev_b32 v126, 16, v9
    v_and_b32 v127, 0xffff0000, v9
    v_pk_mul_f32 v[124:125], v[124:125], s[16:17]
    v_pk_mul_f32 v[126:127], v[126:127], s[16:17]
    v_cvt_pk_bf16_f32 v8, v124, v125
    v_cvt_pk_bf16_f32 v9, v126, v127
    v_lshlrev_b32 v124, 16, v10
    v_and_b32 v125, 0xffff0000, v10
    v_lshlrev_b32 v126, 16, v11
    v_and_b32 v127, 0xffff0000, v11
    v_pk_mul_f32 v[124:125], v[124:125], s[16:17]
    v_pk_mul_f32 v[126:127], v[126:127], s[16:17]
    v_cvt_pk_bf16_f32 v10, v124, v125
    v_cvt_pk_bf16_f32 v11, v126, v127
    v_lshlrev_b32 v124, 16, v12
    v_and_b32 v125, 0xffff0000, v12
    v_lshlrev_b32 v126, 16, v13
    v_and_b32 v127, 0xffff0000, v13
    v_pk_mul_f32 v[124:125], v[124:125], s[16:17]
    v_pk_mul_f32 v[126:127], v[126:127], s[16:17]
    v_cvt_pk_bf16_f32 v12, v124, v125
    v_cvt_pk_bf16_f32 v13, v126, v127
    v_lshlrev_b32 v124, 16, v14
    v_and_b32 v125, 0xffff0000, v14
    v_lshlrev_b32 v126, 16, v15
    v_and_b32 v127, 0xffff0000, v15
    v_pk_mul_f32 v[124:125], v[124:125], s[16:17]
    v_pk_mul_f32 v[126:127], v[126:127], s[16:17]
    v_cvt_pk_bf16_f32 v14, v124, v125
    v_cvt_pk_bf16_f32 v15, v126, v127
    v_lshlrev_b32 v124, 16, v16
    v_and_b32 v125, 0xffff0000, v16
    v_lshlrev_b32 v126, 16, v17
    v_and_b32 v127, 0xffff0000, v17
    v_pk_mul_f32 v[124:125], v[124:125], s[16:17]
    v_pk_mul_f32 v[126:127], v[126:127], s[16:17]
    v_cvt_pk_bf16_f32 v16, v124, v125
    v_cvt_pk_bf16_f32 v17, v126, v127
    v_lshlrev_b32 v124, 16, v18
    v_and_b32 v125, 0xffff0000, v18
    v_lshlrev_b32 v126, 16, v19
    v_and_b32 v127, 0xffff0000, v19
    v_pk_mul_f32 v[124:125], v[124:125], s[16:17]
    v_pk_mul_f32 v[126:127], v[126:127], s[16:17]
    v_cvt_pk_bf16_f32 v18, v124, v125
    v_cvt_pk_bf16_f32 v19, v126, v127
    v_lshlrev_b32 v124, 16, v20
    v_and_b32 v125, 0xffff0000, v20
    v_lshlrev_b32 v126, 16, v21
    v_and_b32 v127, 0xffff0000, v21
    v_pk_mul_f32 v[124:125], v[124:125], s[16:17]
    v_pk_mul_f32 v[126:127], v[126:127], s[16:17]
    v_cvt_pk_bf16_f32 v20, v124, v125
    v_cvt_pk_bf16_f32 v21, v126, v127
    v_lshlrev_b32 v124, 16, v22
    v_and_b32 v125, 0xffff0000, v22
    v_lshlrev_b32 v126, 16, v23
    v_and_b32 v127, 0xffff0000, v23
    v_pk_mul_f32 v[124:125], v[124:125], s[16:17]
    v_pk_mul_f32 v[126:127], v[126:127], s[16:17]
    v_cvt_pk_bf16_f32 v22, v124, v125
    v_cvt_pk_bf16_f32 v23, v126, v127
    s_waitcnt lgkmcnt(0)
    v_mfma_f32_16x16x32_bf16 v[104:107], v[152:155], v[8:11], v[104:107]
    v_mfma_f32_16x16x32_bf16 v[112:115], v[136:139], v[8:11], v[112:115]
    v_mfma_f32_16x16x32_bf16 v[104:107], v[156:159], v[12:15], v[104:107]
    v_mfma_f32_16x16x32_bf16 v[112:115], v[140:143], v[12:15], v[112:115]
    v_mfma_f32_16x16x32_bf16 v[104:107], v[160:163], v[16:19], v[104:107]
    v_mfma_f32_16x16x32_bf16 v[112:115], v[144:147], v[16:19], v[112:115]
    v_mfma_f32_16x16x32_bf16 v[104:107], v[164:167], v[20:23], v[104:107]
    v_mfma_f32_16x16x32_bf16 v[112:115], v[148:151], v[20:23], v[112:115]
    s_nop 6
    v_max3_f32 v124, v104, v105, v106
    v_max3_f32 v124, v124, v107, v112
    v_max3_f32 v124, v124, v113, v114
    v_max_f32 v125, v124, v115
    v_max_f32 v124, v124, v115
    s_nop 1
    v_permlane32_swap_b32 v124, v125
    v_max_f32 v124, v124, v125
    v_max_f32 v125, v124, v125
    s_nop 1
    v_permlane16_swap_b32 v124, v125
    v_max_f32 v124, v124, v125
    v_sub_f32 v128, v128, v124
    v_add_f32 v104, v104, v128
    v_add_f32 v105, v105, v128
    v_add_f32 v106, v106, v128
    v_add_f32 v107, v107, v128
    v_exp_f32 v104, v104
    v_add_f32 v112, v112, v128
    v_exp_f32 v105, v105
    v_add_f32 v113, v113, v128
    v_exp_f32 v106, v106
    v_add_f32 v114, v114, v128
    v_exp_f32 v107, v107
    v_add_f32 v115, v115, v128
    v_exp_f32 v112, v112
    v_add_f32 v4, v4, v104
    v_exp_f32 v113, v113
    v_add_f32 v4, v4, v105
    v_exp_f32 v114, v114
    v_add_f32 v4, v4, v106
    v_exp_f32 v115, v115
    v_add_f32 v4, v4, v107
    v_cvt_pk_bf16_f32 v120, v104, v105
    v_cvt_pk_bf16_f32 v121, v106, v107
    v_add_f32 v4, v4, v112
    v_add_f32 v4, v4, v113
    v_add_f32 v4, v4, v114
    v_add_f32 v4, v4, v115
    v_cvt_pk_bf16_f32 v122, v112, v113
    v_cvt_pk_bf16_f32 v123, v114, v115
    v_lshlrev_b32 v124, 16, v24
    v_and_b32 v125, 0xffff0000, v24
    v_lshlrev_b32 v126, 16, v25
    v_and_b32 v127, 0xffff0000, v25
    v_pk_mul_f32 v[124:125], v[124:125], s[16:17]
    v_pk_mul_f32 v[126:127], v[126:127], s[16:17]
    v_cvt_pk_bf16_f32 v24, v124, v125
    v_cvt_pk_bf16_f32 v25, v126, v127
    v_lshlrev_b32 v124, 16, v26
    v_and_b32 v125, 0xffff0000, v26
    v_lshlrev_b32 v126, 16, v27
    v_and_b32 v127, 0xffff0000, v27
    v_pk_mul_f32 v[124:125], v[124:125], s[16:17]
    v_pk_mul_f32 v[126:127], v[126:127], s[16:17]
    v_cvt_pk_bf16_f32 v26, v124, v125
    v_cvt_pk_bf16_f32 v27, v126, v127
    v_lshlrev_b32 v124, 16, v28
    v_and_b32 v125, 0xffff0000, v28
    v_lshlrev_b32 v126, 16, v29
    v_and_b32 v127, 0xffff0000, v29
    v_pk_mul_f32 v[124:125], v[124:125], s[16:17]
    v_pk_mul_f32 v[126:127], v[126:127], s[16:17]
    v_cvt_pk_bf16_f32 v28, v124, v125
    v_cvt_pk_bf16_f32 v29, v126, v127
    v_lshlrev_b32 v124, 16, v30
    v_and_b32 v125, 0xffff0000, v30
    v_lshlrev_b32 v126, 16, v31
    v_and_b32 v127, 0xffff0000, v31
    v_pk_mul_f32 v[124:125], v[124:125], s[16:17]
    v_pk_mul_f32 v[126:127], v[126:127], s[16:17]
    v_cvt_pk_bf16_f32 v30, v124, v125
    v_cvt_pk_bf16_f32 v31, v126, v127
    v_lshlrev_b32 v124, 16, v32
    v_and_b32 v125, 0xffff0000, v32
    v_lshlrev_b32 v126, 16, v33
    v_and_b32 v127, 0xffff0000, v33
    v_pk_mul_f32 v[124:125], v[124:125], s[16:17]
    v_pk_mul_f32 v[126:127], v[126:127], s[16:17]
    v_cvt_pk_bf16_f32 v32, v124, v125
    v_cvt_pk_bf16_f32 v33, v126, v127
    v_lshlrev_b32 v124, 16, v34
    v_and_b32 v125, 0xffff0000, v34
    v_lshlrev_b32 v126, 16, v35
    v_and_b32 v127, 0xffff0000, v35
    v_pk_mul_f32 v[124:125], v[124:125], s[16:17]
    v_pk_mul_f32 v[126:127], v[126:127], s[16:17]
    v_cvt_pk_bf16_f32 v34, v124, v125
    v_cvt_pk_bf16_f32 v35, v126, v127
    v_lshlrev_b32 v124, 16, v36
    v_and_b32 v125, 0xffff0000, v36
    v_lshlrev_b32 v126, 16, v37
    v_and_b32 v127, 0xffff0000, v37
    v_pk_mul_f32 v[124:125], v[124:125], s[16:17]
    v_pk_mul_f32 v[126:127], v[126:127], s[16:17]
    v_cvt_pk_bf16_f32 v36, v124, v125
    v_cvt_pk_bf16_f32 v37, v126, v127
    v_lshlrev_b32 v124, 16, v38
    v_and_b32 v125, 0xffff0000, v38
    v_lshlrev_b32 v126, 16, v39
    v_and_b32 v127, 0xffff0000, v39
    v_pk_mul_f32 v[124:125], v[124:125], s[16:17]
    v_pk_mul_f32 v[126:127], v[126:127], s[16:17]
    v_cvt_pk_bf16_f32 v38, v124, v125
    v_cvt_pk_bf16_f32 v39, v126, v127
    s_waitcnt lgkmcnt(0)
    v_mfma_f32_16x16x32_bf16 v[108:111], v[152:155], v[24:27], v[108:111]
    v_mfma_f32_16x16x32_bf16 v[116:119], v[136:139], v[24:27], v[116:119]
    v_mfma_f32_16x16x32_bf16 v[108:111], v[156:159], v[28:31], v[108:111]
    v_mfma_f32_16x16x32_bf16 v[116:119], v[140:143], v[28:31], v[116:119]
    v_mfma_f32_16x16x32_bf16 v[108:111], v[160:163], v[32:35], v[108:111]
    v_mfma_f32_16x16x32_bf16 v[116:119], v[144:147], v[32:35], v[116:119]
    v_mfma_f32_16x16x32_bf16 v[108:111], v[164:167], v[36:39], v[108:111]
    v_mfma_f32_16x16x32_bf16 v[116:119], v[148:151], v[36:39], v[116:119]
    s_nop 6
    v_max3_f32 v124, v108, v109, v110
    v_max3_f32 v124, v124, v111, v116
    v_max3_f32 v124, v124, v117, v118
    v_max_f32 v125, v124, v119
    v_max_f32 v124, v124, v119
    s_nop 1
    v_permlane32_swap_b32 v124, v125
    v_max_f32 v124, v124, v125
    v_max_f32 v125, v124, v125
    s_nop 1
    v_permlane16_swap_b32 v124, v125
    v_max_f32 v124, v124, v125
    v_sub_f32 v132, v132, v124
    s_branch L_go
L_lag2:
    s_cmp_eq_u32 s43, 0
    s_cbranch_scc1 L_b9d
L_b9:
    s_barrier
    s_sub_u32 s43, s43, 1
    s_cmp_lg_u32 s43, 0
    s_cbranch_scc1 L_b9
L_b9d:
    s_branch L_sb2
L_lag3:
    s_cmp_eq_u32 s43, 0
    s_cbranch_scc1 L_b10d
L_b10:
    s_barrier
    s_sub_u32 s43, s43, 1
    s_cmp_lg_u32 s43, 0
    s_cbranch_scc1 L_b10
L_b10d:
    s_branch L_sb3
L_loader:
    s_mov_b64 s[12:13], s[6:7]
    s_mov_b64 s[16:17], s[8:9]
    s_mov_b32 s19, 0x20000
    s_add_u32 s14, s24, s25
    s_add_u32 s46, s24, s26
    s_mov_b32 s48, s24
    s_bfe_u32 s38, s32, 0x20006
    s_mul_i32 s44, s38, 2112
    s_add_u32 s49, s44, 16896
    s_lshl_b32 s38, s38, 13
    s_setprio 0
    v_add_u32 v139, s38, v144
    v_add_u32 v140, 3040, v139
    v_add_u32 v8, 0, v139
    v_add_u32 v9, 0, v140
    v_add_u32 v10, 8192, v139
    v_add_u32 v11, 8192, v140
    v_add_u32 v12, 16384, v139
    v_add_u32 v13, 16384, v140
    v_add_u32 v14, 24576, v139
    v_add_u32 v15, 24576, v140
    s_bfe_u32 s34, s28, 0x80008
    s_mov_b32 s40, 0
    s_mov_b32 s50, -1
    s_mov_b32 s51, 0
    s_bfe_u32 s45, s28, 0xe0011
    s_lshr_b32 s38, s27, 4
    s_or_b32 s45, s45, s38
    s_bitcmp1_b32 s28, 5
    s_cbranch_scc0 L_ld_go
    s_waitcnt vmcnt(0)
    s_barrier
L_ld_go:
    s_bitcmp1_b32 s28, 16
    s_cbranch_scc1 L_ld_more1
    s_bitcmp1_b32 s28, 7
    s_cbranch_scc1 L_ld_more4n
    s_branch L_ld_more4
L_ld4:
    s_mov_b32 s47, s46
    s_mov_b32 s18, s14
    s_mov_b32 m0, s49
    s_cmp_eq_u32 s46, s48
    s_cbranch_scc0 L_ld_same4
    s_and_b32 s38, s29, 0x1fff
    s_lshl_b32 s38, s38, 12
    s_add_u32 s48, s38, s33
    s_lshr_b32 s38, s29, 22
    s_max_u32 s38, s38, 1
    s_lshl_b32 s38, s38, 17
    s_add_u32 s46, s48, s38
    s_bfe_u32 s38, s29, 0x9000d
    s_lshl_b32 s38, s38, 12
    s_add_u32 s38, s38, s48
    s_sub_u32 s38, s38, 3840
    s_cmp_eq_u32 s29, 0
    s_cselect_b32 s14, 0, s38
    s_mov_b32 s29, s30
    s_mov_b32 s30, 0
L_ld_same4:
    s_sub_u32 s46, s46, 131072
    buffer_load_dwordx4 v8, s[12:15], s46 offen lds
    buffer_load_dwordx4 v9, s[12:15], s46 offen offset:1056 lds
    s_add_u32 m0, s49, 2112
    s_nop 0
    buffer_load_dwordx4 v10, s[12:15], s46 offen lds
    buffer_load_dwordx4 v11, s[12:15], s46 offen offset:1056 lds
    s_add_u32 m0, s49, 4224
    s_nop 0
    buffer_load_dwordx4 v12, s[12:15], s46 offen lds
    buffer_load_dwordx4 v13, s[12:15], s46 offen offset:1056 lds
    s_add_u32 m0, s49, 6336
    s_nop 0
    buffer_load_dwordx4 v14, s[12:15], s46 offen lds
    buffer_load_dwordx4 v15, s[12:15], s46 offen offset:1056 lds
    s_add_u32 m0, s49, 8448
    s_nop 0
    buffer_load_dwordx4 v8, s[16:19], s47 offen lds
    buffer_load_dwordx4 v9, s[16:19], s47 offen offset:1056 lds
    s_add_u32 m0, s49, 10560
    s_nop 0
    buffer_load_dwordx4 v10, s[16:19], s47 offen lds
    buffer_load_dwordx4 v11, s[16:19], s47 offen offset:1056 lds
    s_add_u32 m0, s49, 12672
    s_nop 0
    buffer_load_dwordx4 v12, s[16:19], s47 offen lds
    buffer_load_dwordx4 v13, s[16:19], s47 offen offset:1056 lds
    s_add_u32 m0, s49, 14784
    s_nop 0
    buffer_load_dwordx4 v14, s[16:19], s47 offen lds
    buffer_load_dwordx4 v15, s[16:19], s47 offen offset:1056 lds
    s_add_u32 s49, s49, 16896
    s_cmp_ge_u32 s49, 101376
    s_cselect_b32 s49, s44, s49
    s_add_u32 s40, s40, 1
L_ld_more4:
    s_cmp_lt_u32 s40, s51
    s_cbranch_scc1 L_ld4
    s_and_b32 s38, s45, 3
    s_xor_b32 s38, s38, 3
    s_add_u32 s38, s38, 2
    s_lshr_b32 s45, s45, 2
    s_bitcmp1_b32 s31, 0
    s_cselect_b32 s38, s38, 5
    s_add_u32 s51, s50, s38
    s_min_u32 s51, s51, s34
    s_ff1_i32_b32 s38, s31
    s_add_u32 s38, s38, 1
    s_lshr_b32 s31, s31, s38
    s_add_u32 s50, s50, s38
    s_sub_u32 s38, s40, s50
    s_waitcnt vmcnt(48)
    s_cmp_ge_u32 s38, 3
    s_cbranch_scc1 L_ld_bar4
    s_waitcnt vmcnt(32)
    s_cmp_ge_u32 s38, 2
    s_cbranch_scc1 L_ld_bar4
    s_waitcnt vmcnt(16)
    s_cmp_ge_u32 s38, 1
    s_cbranch_scc1 L_ld_bar4
    s_waitcnt vmcnt(0)
L_ld_bar4:
    s_barrier
    s_cmp_lt_u32 s50, s34
    s_cbranch_scc1 L_ld_more4
    s_endpgm
L_ld1:
    s_mov_b32 s47, s46
    s_mov_b32 s18, s14
    s_mov_b32 m0, s49
    s_cmp_eq_u32 s46, s48
    s_cbranch_scc0 L_ld_same1
    s_and_b32 s38, s29, 0x1fff
    s_lshl_b32 s38, s38, 12
    s_add_u32 s48, s38, s33
    s_lshr_b32 s38, s29, 22
    s_max_u32 s38, s38, 1
    s_lshl_b32 s38, s38, 17
    s_add_u32 s46, s48, s38
    s_bfe_u32 s38, s29, 0x9000d
    s_lshl_b32 s38, s38, 12
    s_add_u32 s38, s38, s48
    s_sub_u32 s38, s38, 3840
    s_cmp_eq_u32 s29, 0
    s_cselect_b32 s14, 0, s38
    s_mov_b32 s29, s30
    s_mov_b32 s30, 0
L_ld_same1:
    s_sub_u32 s46, s46, 131072
    buffer_load_dwordx4 v8, s[12:15], s46 offen lds
    buffer_load_dwordx4 v9, s[12:15], s46 offen offset:1056 lds
    s_add_u32 m0, s49, 8448
    s_nop 0
    buffer_load_dwordx4 v8, s[16:19], s47 offen lds
    buffer_load_dwordx4 v9, s[16:19], s47 offen offset:1056 lds
    s_add_u32 s49, s49, 16896
    s_cmp_ge_u32 s49, 101376
    s_cselect_b32 s49, s44, s49
    s_add_u32 s40, s40, 1
L_ld_more1:
    s_cmp_lt_u32 s40, s51
    s_cbranch_scc1 L_ld1
    s_and_b32 s38, s45, 3
    s_xor_b32 s38, s38, 3
    s_add_u32 s38, s38, 2
    s_lshr_b32 s45, s45, 2
    s_bitcmp1_b32 s31, 0
    s_cselect_b32 s38, s38, 5
    s_add_u32 s51, s50, s38
    s_min_u32 s51, s51, s34
    s_ff1_i32_b32 s38, s31
    s_add_u32 s38, s38, 1
    s_lshr_b32 s31, s31, s38
    s_add_u32 s50, s50, s38
    s_sub_u32 s38, s40, s50
    s_waitcnt vmcnt(12)
    s_cmp_ge_u32 s38, 3
    s_cbranch_scc1 L_ld_bar1
    s_waitcnt vmcnt(8)
    s_cmp_ge_u32 s38, 2
    s_cbranch_scc1 L_ld_bar1
    s_waitcnt vmcnt(4)
    s_cmp_ge_u32 s38, 1
    s_cbranch_scc1 L_ld_bar1
    s_waitcnt vmcnt(0)
L_ld_bar1:
    s_barrier
    s_cmp_lt_u32 s50, s34
    s_cbranch_scc1 L_ld_more1
    s_endpgm
L_ld4n:
    s_mov_b32 s47, s46
    s_mov_b32 s18, s14
    s_mov_b32 m0, s49
    s_cmp_eq_u32 s46, s48
    s_cbranch_scc0 L_ld_same4n
    s_and_b32 s38, s29, 0x1fff
    s_lshl_b32 s38, s38, 12
    s_add_u32 s48, s38, s33
    s_lshr_b32 s38, s29, 22
    s_max_u32 s38, s38, 1
    s_lshl_b32 s38, s38, 17
    s_add_u32 s46, s48, s38
    s_bfe_u32 s38, s29, 0x9000d
    s_lshl_b32 s38, s38, 12
    s_add_u32 s38, s38, s48
    s_sub_u32 s38, s38, 3840
    s_cmp_eq_u32 s29, 0
    s_cselect_b32 s14, 0, s38
    s_mov_b32 s29, s30
    s_mov_b32 s30, 0
L_ld_same4n:
    s_sub_u32 s46, s46, 131072
    buffer_load_dwordx4 v8, s[12:15], s46 offen nt lds
    buffer_load_dwordx4 v9, s[12:15], s46 offen offset:1056 nt lds
    s_add_u32 m0, s49, 2112
    s_nop 0
    buffer_load_dwordx4 v10, s[12:15], s46 offen nt lds
    buffer_load_dwordx4 v11, s[12:15], s46 offen offset:1056 nt lds
    s_add_u32 m0, s49, 4224
    s_nop 0
    buffer_load_dwordx4 v12, s[12:15], s46 offen nt lds
    buffer_load_dwordx4 v13, s[12:15], s46 offen offset:1056 nt lds
    s_add_u32 m0, s49, 6336
    s_nop 0
    buffer_load_dwordx4 v14, s[12:15], s46 offen nt lds
    buffer_load_dwordx4 v15, s[12:15], s46 offen offset:1056 nt lds
    s_add_u32 m0, s49, 8448
    s_nop 0
    buffer_load_dwordx4 v8, s[16:19], s47 offen nt lds
    buffer_load_dwordx4 v9, s[16:19], s47 offen offset:1056 nt lds
    s_add_u32 m0, s49, 10560
    s_nop 0
    buffer_load_dwordx4 v10, s[16:19], s47 offen nt lds
    buffer_load_dwordx4 v11, s[16:19], s47 offen offset:1056 nt lds
    s_add_u32 m0, s49, 12672
    s_nop 0
    buffer_load_dwordx4 v12, s[16:19], s47 offen nt lds
    buffer_load_dwordx4 v13, s[16:19], s47 offen offset:1056 nt lds
    s_add_u32 m0, s49, 14784
    s_nop 0
    buffer_load_dwordx4 v14, s[16:19], s47 offen nt lds
    buffer_load_dwordx4 v15, s[16:19], s47 offen offset:1056 nt lds
    s_add_u32 s49, s49, 16896
    s_cmp_ge_u32 s49, 101376
    s_cselect_b32 s49, s44, s49
    s_add_u32 s40, s40, 1
L_ld_more4n:
    s_cmp_lt_u32 s40, s51
    s_cbranch_scc1 L_ld4n
    s_and_b32 s38, s45, 3
    s_xor_b32 s38, s38, 3
    s_add_u32 s38, s38, 2
    s_lshr_b32 s45, s45, 2
    s_bitcmp1_b32 s31, 0
    s_cselect_b32 s38, s38, 5
    s_add_u32 s51, s50, s38
    s_min_u32 s51, s51, s34
    s_ff1_i32_b32 s38, s31
    s_add_u32 s38, s38, 1
    s_lshr_b32 s31, s31, s38
    s_add_u32 s50, s50, s38
    s_sub_u32 s38, s40, s50
    s_waitcnt vmcnt(48)
    s_cmp_ge_u32 s38, 3
    s_cbranch_scc1 L_ld_bar4n
    s_waitcnt vmcnt(32)
    s_cmp_ge_u32 s38, 2
    s_cbranch_scc1 L_ld_bar4n
    s_waitcnt vmcnt(16)
    s_cmp_ge_u32 s38, 1
    s_cbranch_scc1 L_ld_bar4n
    s_waitcnt vmcnt(0)
L_ld_bar4n:
    s_barrier
    s_cmp_lt_u32 s50, s34
    s_cbranch_scc1 L_ld_more4n
    s_endpgm
L_exact:
    s_waitcnt vmcnt(0)
    s_add_u32 s12, s4, s24
    s_addc_u32 s13, s5, 0
    s_add_u32 s16, s6, s24
    s_addc_u32 s17, s7, 0
    s_mov_b32 s18, s25
    s_mov_b32 s19, 0x20000
    s_add_u32 s20, s8, s24
    s_addc_u32 s21, s9, 0
    s_mov_b32 s22, s25
    s_mov_b32 s23, 0x20000
    v_mbcnt_lo_u32_b32 v128, -1, 0
    v_mbcnt_hi_u32_b32 v128, -1, v128
    v_lshrrev_b32 v0, 5, v128
    v_lshlrev_b32 v132, 2, v0
    v_and_b32 v129, 31, v128
    v_lshlrev_b32 v129, 12, v129
    v_lshl_add_u32 v129, v0, 4, v129
    v_lshrrev_b32 v1, 4, v128
    v_and_b32 v130, 15, v128
    v_lshlrev_b32 v130, 4, v130
    v_lshl_add_u32 v130, v1, 12, v130
    v_bfe_u32 v131, v128, 2, 2
    v_add_u32 v131, v131, v132
    v_lshlrev_b32 v131, 8, v131
    v_and_b32 v1, 1, v1
    v_lshl_add_u32 v131, v1, 5, v131
    v_and_b32 v1, 1, v128
    v_lshl_add_u32 v131, v1, 4, v131
    v_and_b32 v1, 2, v128
    v_lshl_add_u32 v131, v1, 2, v131
    v_add_u32 v131, s29, v131
    v_mov_b32 v133, 0xff800000
    v_mov_b32 v134, 0xff800000
    v_mov_b32 v4, 0
    s_mov_b32 s36, 0
    s_add_u32 s34, s25, 3840
    s_lshr_b32 s34, s34, 12
    buffer_load_dwordx4 v[8:11], v129, s[12:15], s26 offen offset:0
    buffer_load_dwordx4 v[12:15], v129, s[12:15], s26 offen offset:32
    buffer_load_dwordx4 v[16:19], v129, s[12:15], s26 offen offset:64
    buffer_load_dwordx4 v[20:23], v129, s[12:15], s26 offen offset:96
    buffer_load_dwordx4 v[24:27], v129, s[12:15], s26 offen offset:128
    buffer_load_dwordx4 v[28:31], v129, s[12:15], s26 offen offset:160
    buffer_load_dwordx4 v[32:35], v129, s[12:15], s26 offen offset:192
    buffer_load_dwordx4 v[36:39], v129, s[12:15], s26 offen offset:224
    v_mov_b32 v40, 0
    v_mov_b32 v41, 0
    v_mov_b32 v42, 0
    v_mov_b32 v43, 0
    v_mov_b32 v44, 0
    v_mov_b32 v45, 0
    v_mov_b32 v46, 0
    v_mov_b32 v47, 0
    v_mov_b32 v48, 0
    v_mov_b32 v49, 0
    v_mov_b32 v50, 0
    v_mov_b32 v51, 0
    v_mov_b32 v52, 0
    v_mov_b32 v53, 0
    v_mov_b32 v54, 0
    v_mov_b32 v55, 0
    v_mov_b32 v56, 0
    v_mov_b32 v57, 0
    v_mov_b32 v58, 0
    v_mov_b32 v59, 0
    v_mov_b32 v60, 0
    v_mov_b32 v61, 0
    v_mov_b32 v62, 0
    v_mov_b32 v63, 0
    v_mov_b32 v64, 0
    v_mov_b32 v65, 0
    v_mov_b32 v66, 0
    v_mov_b32 v67, 0
    v_mov_b32 v68, 0
    v_mov_b32 v69, 0
    v_mov_b32 v70, 0
    v_mov_b32 v71, 0
    v_mov_b32 v72, 0
    v_mov_b32 v73, 0
    v_mov_b32 v74, 0
    v_mov_b32 v75, 0
    v_mov_b32 v76, 0
    v_mov_b32 v77, 0
    v_mov_b32 v78, 0
    v_mov_b32 v79, 0
    v_mov_b32 v80, 0
    v_mov_b32 v81, 0
    v_mov_b32 v82, 0
    v_mov_b32 v83, 0
    v_mov_b32 v84, 0
    v_mov_b32 v85, 0
    v_mov_b32 v86, 0
    v_mov_b32 v87, 0
    v_mov_b32 v88, 0
    v_mov_b32 v89, 0
    v_mov_b32 v90, 0
    v_mov_b32 v91, 0
    v_mov_b32 v92, 0
    v_mov_b32 v93, 0
    v_mov_b32 v94, 0
    v_mov_b32 v95, 0
    v_mov_b32 v96, 0
    v_mov_b32 v97, 0
    v_mov_b32 v98, 0
    v_mov_b32 v99, 0
    v_mov_b32 v100, 0
    v_mov_b32 v101, 0
    v_mov_b32 v102, 0
    v_mov_b32 v103, 0
L_ex_loop:
    buffer_load_dwordx4 v[136:139], v129, s[16:19], s36 offen offset:0
    buffer_load_dwordx4 v[140:143], v129, s[16:19], s36 offen offset:32
    buffer_load_dwordx4 v[144:147], v129, s[16:19], s36 offen offset:64
    buffer_load_dwordx4 v[148:151], v129, s[16:19], s36 offen offset:96
    buffer_load_dwordx4 v[152:155], v129, s[16:19], s36 offen offset:128
    buffer_load_dwordx4 v[156:159], v129, s[16:19], s36 offen offset:160
    buffer_load_dwordx4 v[160:163], v129, s[16:19], s36 offen offset:192
    buffer_load_dwordx4 v[164:167], v129, s[16:19], s36 offen offset:224
    v_sub_u32 v2, s34, v132
    s_waitcnt vmcnt(0)
    v_mfma_f32_32x32x16_bf16 v[104:119], v[136:139], v[8:11], 0
    v_mfma_f32_32x32x16_bf16 v[104:119], v[140:143], v[12:15], v[104:119]
    v_mfma_f32_32x32x16_bf16 v[104:119], v[144:147], v[16:19], v[104:119]
    v_mfma_f32_32x32x16_bf16 v[104:119], v[148:151], v[20:23], v[104:119]
    v_mfma_f32_32x32x16_bf16 v[104:119], v[152:155], v[24:27], v[104:119]
    v_mfma_f32_32x32x16_bf16 v[104:119], v[156:159], v[28:31], v[104:119]
    v_mfma_f32_32x32x16_bf16 v[104:119], v[160:163], v[32:35], v[104:119]
    v_mfma_f32_32x32x16_bf16 v[104:119], v[164:167], v[36:39], v[104:119]
    s_nop 11
    v_cmp_ge_i32 s[44:45], 0, v2
    v_cmp_ge_i32 s[46:47], 1, v2
    v_cmp_ge_i32 s[48:49], 2, v2
    v_cmp_ge_i32 s[50:51], 3, v2
    v_cndmask_b32 v104, v104, v133, s[44:45]
    v_cndmask_b32 v105, v105, v133, s[46:47]
    v_cndmask_b32 v106, v106, v133, s[48:49]
    v_cndmask_b32 v107, v107, v133, s[50:51]
    v_cmp_ge_i32 s[44:45], 8, v2
    v_cmp_ge_i32 s[46:47], 9, v2
    v_cmp_ge_i32 s[48:49], 10, v2
    v_cmp_ge_i32 s[50:51], 11, v2
    v_cndmask_b32 v108, v108, v133, s[44:45]
    v_cndmask_b32 v109, v109, v133, s[46:47]
    v_cndmask_b32 v110, v110, v133, s[48:49]
    v_cndmask_b32 v111, v111, v133, s[50:51]
    v_cmp_ge_i32 s[44:45], 16, v2
    v_cmp_ge_i32 s[46:47], 17, v2
    v_cmp_ge_i32 s[48:49], 18, v2
    v_cmp_ge_i32 s[50:51], 19, v2
    v_cndmask_b32 v112, v112, v133, s[44:45]
    v_cndmask_b32 v113, v113, v133, s[46:47]
    v_cndmask_b32 v114, v114, v133, s[48:49]
    v_cndmask_b32 v115, v115, v133, s[50:51]
    v_cmp_ge_i32 s[44:45], 24, v2
    v_cmp_ge_i32 s[46:47], 25, v2
    v_cmp_ge_i32 s[48:49], 26, v2
    v_cmp_ge_i32 s[50:51], 27, v2
    v_cndmask_b32 v116, v116, v133, s[44:45]
    v_cndmask_b32 v117, v117, v133, s[46:47]
    v_cndmask_b32 v118, v118, v133, s[48:49]
    v_cndmask_b32 v119, v119, v133, s[50:51]
    v_max3_f32 v0, v104, v105, v106
    v_max3_f32 v0, v0, v107, v108
    v_max3_f32 v0, v0, v109, v110
    v_max3_f32 v0, v0, v111, v112
    v_max3_f32 v0, v0, v113, v114
    v_max3_f32 v0, v0, v115, v116
    v_max3_f32 v0, v0, v117, v118
    v_max_f32 v0, v0, v119
    v_mov_b32 v1, v0
    s_nop 1
    v_permlane32_swap_b32 v0, v1
    v_max_f32 v0, v0, v1
    v_mul_f32 v0, 0x3e0293ee, v0
    v_max_f32 v0, v0, v134
    v_sub_f32 v135, v134, v0
    v_exp_f32 v135, v135
    v_mov_b32 v134, v0
    v_sub_f32 v3, 0, v0
    v_mul_f32 v4, v4, v135
    v_fmamk_f32 v104, v104, 0x3e0293ee, v3
    v_fmamk_f32 v105, v105, 0x3e0293ee, v3
    v_fmamk_f32 v106, v106, 0x3e0293ee, v3
    v_fmamk_f32 v107, v107, 0x3e0293ee, v3
    v_fmamk_f32 v108, v108, 0x3e0293ee, v3
    v_fmamk_f32 v109, v109, 0x3e0293ee, v3
    v_fmamk_f32 v110, v110, 0x3e0293ee, v3
    v_fmamk_f32 v111, v111, 0x3e0293ee, v3
    v_fmamk_f32 v112, v112, 0x3e0293ee, v3
    v_fmamk_f32 v113, v113, 0x3e0293ee, v3
    v_fmamk_f32 v114, v114, 0x3e0293ee, v3
    v_fmamk_f32 v115, v115, 0x3e0293ee, v3
    v_fmamk_f32 v116, v116, 0x3e0293ee, v3
    v_fmamk_f32 v117, v117, 0x3e0293ee, v3
    v_fmamk_f32 v118, v118, 0x3e0293ee, v3
    v_fmamk_f32 v119, v119, 0x3e0293ee, v3
    v_exp_f32 v104, v104
    v_exp_f32 v105, v105
    v_exp_f32 v106, v106
    v_exp_f32 v107, v107
    v_exp_f32 v108, v108
    v_exp_f32 v109, v109
    v_exp_f32 v110, v110
    v_exp_f32 v111, v111
    v_exp_f32 v112, v112
    v_exp_f32 v113, v113
    v_exp_f32 v114, v114
    v_exp_f32 v115, v115
    v_exp_f32 v116, v116
    v_exp_f32 v117, v117
    v_exp_f32 v118, v118
    v_exp_f32 v119, v119
    v_mul_f32 v40, v40, v135
    v_mul_f32 v41, v41, v135
    v_mul_f32 v42, v42, v135
    v_mul_f32 v43, v43, v135
    v_mul_f32 v44, v44, v135
    v_mul_f32 v45, v45, v135
    v_mul_f32 v46, v46, v135
    v_mul_f32 v47, v47, v135
    v_mul_f32 v48, v48, v135
    v_mul_f32 v49, v49, v135
    v_mul_f32 v50, v50, v135
    v_mul_f32 v51, v51, v135
    v_mul_f32 v52, v52, v135
    v_mul_f32 v53, v53, v135
    v_mul_f32 v54, v54, v135
    v_mul_f32 v55, v55, v135
    v_mul_f32 v56, v56, v135
    v_mul_f32 v57, v57, v135
    v_mul_f32 v58, v58, v135
    v_mul_f32 v59, v59, v135
    v_mul_f32 v60, v60, v135
    v_mul_f32 v61, v61, v135
    v_mul_f32 v62, v62, v135
    v_mul_f32 v63, v63, v135
    v_mul_f32 v64, v64, v135
    v_mul_f32 v65, v65, v135
    v_mul_f32 v66, v66, v135
    v_mul_f32 v67, v67, v135
    v_mul_f32 v68, v68, v135
    v_mul_f32 v69, v69, v135
    v_mul_f32 v70, v70, v135
    v_mul_f32 v71, v71, v135
    v_mul_f32 v72, v72, v135
    v_mul_f32 v73, v73, v135
    v_mul_f32 v74, v74, v135
    v_mul_f32 v75, v75, v135
    v_mul_f32 v76, v76, v135
    v_mul_f32 v77, v77, v135
    v_mul_f32 v78, v78, v135
    v_mul_f32 v79, v79, v135
    v_mul_f32 v80, v80, v135
    v_mul_f32 v81, v81, v135
    v_mul_f32 v82, v82, v135
    v_mul_f32 v83, v83, v135
    v_mul_f32 v84, v84, v135
    v_mul_f32 v85, v85, v135
    v_mul_f32 v86, v86, v135
    v_mul_f32 v87, v87, v135
    v_mul_f32 v88, v88, v135
    v_mul_f32 v89, v89, v135
    v_mul_f32 v90, v90, v135
    v_mul_f32 v91, v91, v135
    v_mul_f32 v92, v92, v135
    v_mul_f32 v93, v93, v135
    v_mul_f32 v94, v94, v135
    v_mul_f32 v95, v95, v135
    v_mul_f32 v96, v96, v135
    v_mul_f32 v97, v97, v135
    v_mul_f32 v98, v98, v135
    v_mul_f32 v99, v99, v135
    v_mul_f32 v100, v100, v135
    v_mul_f32 v101, v101, v135
    v_mul_f32 v102, v102, v135
    v_mul_f32 v103, v103, v135
    v_add_f32 v4, v4, v104
    v_add_f32 v4, v4, v105
    v_add_f32 v4, v4, v106
    v_add_f32 v4, v4, v107
    v_add_f32 v4, v4, v108
    v_add_f32 v4, v4, v109
    v_add_f32 v4, v4, v110
    v_add_f32 v4, v4, v111
    v_add_f32 v4, v4, v112
    v_add_f32 v4, v4, v113
    v_add_f32 v4, v4, v114
    v_add_f32 v4, v4, v115
    v_add_f32 v4, v4, v116
    v_add_f32 v4, v4, v117
    v_add_f32 v4, v4, v118
    v_add_f32 v4, v4, v119
    v_cvt_pk_bf16_f32 v120, v104, v105
    v_cvt_pk_bf16_f32 v121, v106, v107
    v_cvt_pk_bf16_f32 v122, v108, v109
    v_cvt_pk_bf16_f32 v123, v110, v111
    v_cvt_pk_bf16_f32 v124, v112, v113
    v_cvt_pk_bf16_f32 v125, v114, v115
    v_cvt_pk_bf16_f32 v126, v116, v117
    v_cvt_pk_bf16_f32 v127, v118, v119
    s_add_u32 m0, s29, 0
    s_add_u32 s38, s36, 0
    buffer_load_dwordx4 v130, s[20:23], s38 offen lds
    s_add_u32 m0, s29, 1024
    s_add_u32 s38, s36, 16384
    buffer_load_dwordx4 v130, s[20:23], s38 offen lds
    s_add_u32 m0, s29, 2048
    s_add_u32 s38, s36, 32768
    buffer_load_dwordx4 v130, s[20:23], s38 offen lds
    s_add_u32 m0, s29, 3072
    s_add_u32 s38, s36, 49152
    buffer_load_dwordx4 v130, s[20:23], s38 offen lds
    s_waitcnt vmcnt(0)
    ds_read_b64_tr_b16 v[136:137], v131 offset:0
    ds_read_b64_tr_b16 v[138:139], v131 offset:2048
    ds_read_b64_tr_b16 v[140:141], v131 offset:64
    ds_read_b64_tr_b16 v[142:143], v131 offset:2112
    ds_read_b64_tr_b16 v[144:145], v131 offset:128
    ds_read_b64_tr_b16 v[146:147], v131 offset:2176
    ds_read_b64_tr_b16 v[148:149], v131 offset:192
    ds_read_b64_tr_b16 v[150:151], v131 offset:2240
    s_waitcnt lgkmcnt(0)
    v_mfma_f32_32x32x16_bf16 v[40:55], v[136:139], v[120:123], v[40:55]
    v_mfma_f32_32x32x16_bf16 v[56:71], v[140:143], v[120:123], v[56:71]
    v_mfma_f32_32x32x16_bf16 v[72:87], v[144:147], v[120:123], v[72:87]
    v_mfma_f32_32x32x16_bf16 v[88:103], v[148:151], v[120:123], v[88:103]
    s_add_u32 m0, s29, 0
    s_add_u32 s38, s36, 65536
    buffer_load_dwordx4 v130, s[20:23], s38 offen lds
    s_add_u32 m0, s29, 1024
    s_add_u32 s38, s36, 81920
    buffer_load_dwordx4 v130, s[20:23], s38 offen lds
    s_add_u32 m0, s29, 2048
    s_add_u32 s38, s36, 98304
    buffer_load_dwordx4 v130, s[20:23], s38 offen lds
    s_add_u32 m0, s29, 3072
    s_add_u32 s38, s36, 114688
    buffer_load_dwordx4 v130, s[20:23], s38 offen lds
    s_waitcnt vmcnt(0)
    ds_read_b64_tr_b16 v[152:153], v131 offset:0
    ds_read_b64_tr_b16 v[154:155], v131 offset:2048
    ds_read_b64_tr_b16 v[156:157], v131 offset:64
    ds_read_b64_tr_b16 v[158:159], v131 offset:2112
    ds_read_b64_tr_b16 v[160:161], v131 offset:128
    ds_read_b64_tr_b16 v[162:163], v131 offset:2176
    ds_read_b64_tr_b16 v[164:165], v131 offset:192
    ds_read_b64_tr_b16 v[166:167], v131 offset:2240
    s_waitcnt lgkmcnt(0)
    v_mfma_f32_32x32x16_bf16 v[40:55], v[152:155], v[124:127], v[40:55]
    v_mfma_f32_32x32x16_bf16 v[56:71], v[156:159], v[124:127], v[56:71]
    v_mfma_f32_32x32x16_bf16 v[72:87], v[160:163], v[124:127], v[72:87]
    v_mfma_f32_32x32x16_bf16 v[88:103], v[164:167], v[124:127], v[88:103]
    s_add_u32 s36, s36, 131072
    s_sub_i32 s34, s34, 32
    s_cmp_gt_i32 s34, 0
    s_cbranch_scc1 L_ex_loop
    v_mov_b32 v0, v4
    s_add_u32 s12, s10, s24
    s_addc_u32 s13, s11, 0
    v_permlane32_swap_b32 v0, v4
    v_add_f32 v4, v4, v0
    v_rcp_f32 v4, v4
    s_nop 7
    v_mul_f32 v40, v40, v4
    v_mul_f32 v41, v41, v4
    v_mul_f32 v42, v42, v4
    v_mul_f32 v43, v43, v4
    v_mul_f32 v44, v44, v4
    v_mul_f32 v45, v45, v4
    v_mul_f32 v46, v46, v4
    v_mul_f32 v47, v47, v4
    v_mul_f32 v48, v48, v4
    v_mul_f32 v49, v49, v4
    v_mul_f32 v50, v50, v4
    v_mul_f32 v51, v51, v4
    v_mul_f32 v52, v52, v4
    v_mul_f32 v53, v53, v4
    v_mul_f32 v54, v54, v4
    v_mul_f32 v55, v55, v4
    v_mul_f32 v56, v56, v4
    v_mul_f32 v57, v57, v4
    v_mul_f32 v58, v58, v4
    v_mul_f32 v59, v59, v4
    v_mul_f32 v60, v60, v4
    v_mul_f32 v61, v61, v4
    v_mul_f32 v62, v62, v4
    v_mul_f32 v63, v63, v4
    v_mul_f32 v64, v64, v4
    v_mul_f32 v65, v65, v4
    v_mul_f32 v66, v66, v4
    v_mul_f32 v67, v67, v4
    v_mul_f32 v68, v68, v4
    v_mul_f32 v69, v69, v4
    v_mul_f32 v70, v70, v4
    v_mul_f32 v71, v71, v4
    v_mul_f32 v72, v72, v4
    v_mul_f32 v73, v73, v4
    v_mul_f32 v74, v74, v4
    v_mul_f32 v75, v75, v4
    v_mul_f32 v76, v76, v4
    v_mul_f32 v77, v77, v4
    v_mul_f32 v78, v78, v4
    v_mul_f32 v79, v79, v4
    v_mul_f32 v80, v80, v4
    v_mul_f32 v81, v81, v4
    v_mul_f32 v82, v82, v4
    v_mul_f32 v83, v83, v4
    v_mul_f32 v84, v84, v4
    v_mul_f32 v85, v85, v4
    v_mul_f32 v86, v86, v4
    v_mul_f32 v87, v87, v4
    v_mul_f32 v88, v88, v4
    v_mul_f32 v89, v89, v4
    v_mul_f32 v90, v90, v4
    v_mul_f32 v91, v91, v4
    v_mul_f32 v92, v92, v4
    v_mul_f32 v93, v93, v4
    v_mul_f32 v94, v94, v4
    v_mul_f32 v95, v95, v4
    v_mul_f32 v96, v96, v4
    v_mul_f32 v97, v97, v4
    v_mul_f32 v98, v98, v4
    v_mul_f32 v99, v99, v4
    v_mul_f32 v100, v100, v4
    v_mul_f32 v101, v101, v4
    v_mul_f32 v102, v102, v4
    v_mul_f32 v103, v103, v4
    v_cvt_pk_bf16_f32 v8, v40, v41
    v_cvt_pk_bf16_f32 v9, v42, v43
    v_cvt_pk_bf16_f32 v10, v44, v45
    v_cvt_pk_bf16_f32 v11, v46, v47
    v_cvt_pk_bf16_f32 v12, v48, v49
    v_cvt_pk_bf16_f32 v13, v50, v51
    v_cvt_pk_bf16_f32 v14, v52, v53
    v_cvt_pk_bf16_f32 v15, v54, v55
    v_cvt_pk_bf16_f32 v16, v56, v57
    v_cvt_pk_bf16_f32 v17, v58, v59
    v_cvt_pk_bf16_f32 v18, v60, v61
    v_cvt_pk_bf16_f32 v19, v62, v63
    v_cvt_pk_bf16_f32 v20, v64, v65
    v_cvt_pk_bf16_f32 v21, v66, v67
    v_cvt_pk_bf16_f32 v22, v68, v69
    v_cvt_pk_bf16_f32 v23, v70, v71
    v_cvt_pk_bf16_f32 v24, v72, v73
    v_cvt_pk_bf16_f32 v25, v74, v75
    v_cvt_pk_bf16_f32 v26, v76, v77
    v_cvt_pk_bf16_f32 v27, v78, v79
    v_cvt_pk_bf16_f32 v28, v80, v81
    v_cvt_pk_bf16_f32 v29, v82, v83
    v_cvt_pk_bf16_f32 v30, v84, v85
    v_cvt_pk_bf16_f32 v31, v86, v87
    v_cvt_pk_bf16_f32 v32, v88, v89
    v_cvt_pk_bf16_f32 v33, v90, v91
    v_cvt_pk_bf16_f32 v34, v92, v93
    v_cvt_pk_bf16_f32 v35, v94, v95
    v_cvt_pk_bf16_f32 v36, v96, v97
    v_cvt_pk_bf16_f32 v37, v98, v99
    v_cvt_pk_bf16_f32 v38, v100, v101
    v_cvt_pk_bf16_f32 v39, v102, v103
    buffer_store_dwordx4 v[8:11], v129, s[12:15], s26 offen offset:0
    buffer_store_dwordx4 v[12:15], v129, s[12:15], s26 offen offset:32
    buffer_store_dwordx4 v[16:19], v129, s[12:15], s26 offen offset:64
    buffer_store_dwordx4 v[20:23], v129, s[12:15], s26 offen offset:96
    buffer_store_dwordx4 v[24:27], v129, s[12:15], s26 offen offset:128
    buffer_store_dwordx4 v[28:31], v129, s[12:15], s26 offen offset:160
    buffer_store_dwordx4 v[32:35], v129, s[12:15], s26 offen offset:192
    buffer_store_dwordx4 v[36:39], v129, s[12:15], s26 offen offset:224
    s_branch L_rest
.p2align 6
L_tab:
.long 0x842000, 0x13a100, 0x120000, 0x0, 0x55520a80, 0x0, 0x0, 0x5ff
.long 0x842000, 0x13a100, 0x0, 0x18c00, 0x6d1000, 0x18c00, 0x44464ccc, 0x0
.long 0x842000, 0x13a100, 0x20000, 0x1ad00, 0x6d1000, 0x19d00, 0x44464ccc, 0x0
.long 0x842000, 0x13a100, 0x40000, 0x1ce00, 0x6d1000, 0x1ae00, 0x44464ccc, 0x0
.long 0x842000, 0x13a100, 0x60000, 0x1ef00, 0x6d1000, 0x1bf00, 0x44464ccc, 0x0
.long 0x842000, 0x13a100, 0x80000, 0x21000, 0x6d1000, 0x1d000, 0x44464ccc, 0x0
.long 0x842000, 0x13a100, 0xa0000, 0x23100, 0x6d1000, 0x1e100, 0x44464ccc, 0x0
.long 0x842000, 0x13a100, 0xc0000, 0x25200, 0x6d1000, 0x1f200, 0x44464ccc, 0x0
.long 0x842000, 0x13a100, 0xe0000, 0x10800, 0x6d1000, 0x20300, 0x44464ccc, 0x0
.long 0x842000, 0x13a100, 0x100000, 0x12900, 0x6d1000, 0x21400, 0x44464ccc, 0x0
.long 0x842000, 0x13a100, 0x120000, 0x14a00, 0x6d1000, 0x22500, 0x44464ccc, 0x0
.long 0x0, 0x0, 0x0, 0x0, 0x1f, 0x0, 0x0, 0x0
.long 0x778000, 0xc9100, 0xc0000, 0x0, 0x52d21380, 0x32e84bb, 0x0, 0xffd79
.long 0x778000, 0xc9100, 0x0, 0x18c00, 0xa281000, 0x18c00, 0x644dd, 0x0
.long 0x778000, 0xc9100, 0x20000, 0x1ad00, 0xa281000, 0x19d00, 0x644dd, 0x0
.long 0x778000, 0xc9100, 0x40000, 0x1ce00, 0xa281000, 0x1ae00, 0x644dd, 0x0
.long 0x778000, 0xc9100, 0x60000, 0x1ef00, 0xa281000, 0x1bf00, 0x644dd, 0x0
.long 0x778000, 0xc9100, 0x80000, 0x21000, 0xa281000, 0x1d000, 0x644dd, 0x0
.long 0x778000, 0xc9100, 0xa0000, 0x23100, 0xa281000, 0x1e100, 0x644dd, 0x0
.long 0x778000, 0xc9100, 0xc0000, 0x25200, 0xa281000, 0x1f200, 0x644dd, 0x0
.long 0x4bb000, 0x173100, 0x100000, 0x25200, 0x5081a2, 0x60300, 0x44446454, 0x64
.long 0x4bb000, 0x173100, 0x120000, 0x23100, 0x508142, 0x61400, 0x44446454, 0x64
.long 0x4bb000, 0x173100, 0x140000, 0x21000, 0x5080e2, 0x62500, 0x44446454, 0x64
.long 0x4bb000, 0x173100, 0x160000, 0x1ef00, 0x5080e2, 0x63600, 0x44446454, 0x64
.long 0x0, 0xcc100, 0xc0000, 0x0, 0x17fa1280, 0x2e9262f, 0x0, 0x4ffff
.long 0x0, 0xcc100, 0x0, 0x18c00, 0x9340000, 0x18c00, 0x64ccc, 0x0
.long 0x0, 0xcc100, 0x20000, 0x1ad00, 0x9340000, 0x19d00, 0x64ccc, 0x0
.long 0x0, 0xcc100, 0x40000, 0x1ce00, 0x9340000, 0x1ae00, 0x64ccc, 0x0
.long 0x0, 0xcc100, 0x60000, 0x1ef00, 0x9340000, 0x1bf00, 0x64ccc, 0x0
.long 0x0, 0xcc100, 0x80000, 0x21000, 0x9340000, 0x1d000, 0x64ccc, 0x0
.long 0x0, 0xcc100, 0xa0000, 0x23100, 0x9340000, 0x1e100, 0x64ccc, 0x0
.long 0x0, 0xcc100, 0xc0000, 0x25200, 0x9340000, 0x1f200, 0x64ccc, 0x0
.long 0x62f000, 0x148100, 0xe0000, 0x25200, 0x254163, 0x60300, 0x44446444, 0x5
.long 0x62f000, 0x148100, 0x100000, 0x23100, 0x2540e4, 0x61400, 0x44446444, 0x5
.long 0x62f000, 0x148100, 0x120000, 0x21000, 0x2540e4, 0x62500, 0x44446444, 0x5
.long 0x62f000, 0x148100, 0x140000, 0x1ef00, 0x2540e4, 0x63600, 0x44446444, 0x5
.long 0xe6c000, 0x1b8100, 0x1a0000, 0x0, 0xc5120e20, 0x0, 0x0, 0x7fff
.long 0xe6c000, 0x1b8100, 0x0, 0x18c00, 0x641060, 0x18c00, 0x444644cc, 0x4644
.long 0xe6c000, 0x1b8100, 0x20000, 0x1ad00, 0x641060, 0x19d00, 0x444644cc, 0x4644
.long 0xe6c000, 0x1b8100, 0x40000, 0x1ce00, 0x641060, 0x1ae00, 0x444644cc, 0x4644
.long 0xe6c000, 0x1b8100, 0x60000, 0x1ef00, 0x641060, 0x1bf00, 0x444644cc, 0x4644
.long 0xe6c000, 0x1b8100, 0x80000, 0x21000, 0x60651060, 0x1d000, 0x444644cc, 0x5744
.long 0xe6c000, 0x1b8100, 0xa0000, 0x23100, 0x60651060, 0x1e100, 0x444644cc, 0x5744
.long 0x0, 0x0, 0x0, 0x0, 0x1f, 0x0, 0x0, 0x0
.long 0x0, 0x0, 0x0, 0x0, 0x1f, 0x0, 0x0, 0x0
.long 0x0, 0x0, 0x0, 0x0, 0x1f, 0x0, 0x0, 0x0
.long 0x0, 0x0, 0x0, 0x0, 0x1f, 0x0, 0x0, 0x0
.long 0x0, 0x0, 0x0, 0x0, 0x1f, 0x0, 0x0, 0x0
.long 0xcd000, 0x13a100, 0x120000, 0x0, 0x33f40a80, 0x0, 0x0, 0x5ff
.long 0xcd000, 0x13a100, 0x0, 0x18c00, 0x6d0000, 0x18c00, 0x444644cc, 0x0
.long 0xcd000, 0x13a100, 0x20000, 0x1ad00, 0x6d0000, 0x19d00, 0x444644cc, 0x0
.long 0xcd000, 0x13a100, 0x40000, 0x1ce00, 0x6d0000, 0x1ae00, 0x444644cc, 0x0
.long 0xcd000, 0x13a100, 0x60000, 0x1ef00, 0x6d0000, 0x1bf00, 0x444644cc, 0x0
.long 0xcd000, 0x13a100, 0x80000, 0x21000, 0x6d0000, 0x1d000, 0x444644cc, 0x0
.long 0xcd000, 0x13a100, 0xa0000, 0x23100, 0x6d0000, 0x1e100, 0x444644cc, 0x0
.long 0xcd000, 0x13a100, 0xc0000, 0x25200, 0x6d0000, 0x1f200, 0x444644cc, 0x0
.long 0xcd000, 0x13a100, 0xe0000, 0x10800, 0x6d0000, 0x20300, 0x444644cc, 0x0
.long 0xcd000, 0x13a100, 0x100000, 0x12900, 0x6d0000, 0x21400, 0x444644cc, 0x0
.long 0xcd000, 0x13a100, 0x120000, 0x14a00, 0x6d0000, 0x22500, 0x444644cc, 0x0
.long 0x0, 0x0, 0x0, 0x0, 0x1f, 0x0, 0x0, 0x0
.long 0xc1b000, 0x1ed100, 0x1e0000, 0x55680000, 0x35431000, 0x0, 0x0, 0x1ffff
.long 0xc1b000, 0x1ed100, 0x0, 0x18c00, 0x380000, 0x18c00, 0x44464444, 0x444644
.long 0xc1b000, 0x1ed100, 0x20000, 0x1ad00, 0x380000, 0x19d00, 0x44464444, 0x444644
.long 0xc1b000, 0x1ed100, 0x40000, 0x1ce00, 0x380000, 0x1ae00, 0x44464444, 0x444644
.long 0xc1b000, 0x1ed100, 0x60000, 0x1ef00, 0x380000, 0x1bf00, 0x44464444, 0x444644
.long 0xc1b000, 0x1ed100, 0x80000, 0x21000, 0x60390000, 0x1d000, 0x44464444, 0x554644
.long 0xc1b000, 0x1ed100, 0xa0000, 0x23100, 0x60390000, 0x1e100, 0x44464444, 0x554644
.long 0xc1b000, 0x1ed100, 0xc0000, 0x25200, 0x60391000, 0x1f200, 0x44464444, 0x554644
.long 0xc1b000, 0x1ed100, 0xe0000, 0x10800, 0x60391000, 0x20300, 0x44464444, 0x554644
.long 0xc1b000, 0x1ed100, 0x1e0000, 0x55680000, 0x3543101e, 0x0, 0x0, 0x1ffff
.long 0xc1b000, 0x1ed100, 0x1e0000, 0x55680000, 0x3543101e, 0x0, 0x0, 0x1ffff
.long 0xc1b000, 0x1ed100, 0x1e0000, 0x55680000, 0x3543101e, 0x0, 0x0, 0x1ffff
.long 0x97d000, 0x1cf100, 0x1c0000, 0x0, 0x5d520f00, 0x0, 0x0, 0x9ff9
.long 0x97d000, 0x1cf100, 0x0, 0x18c00, 0x410000, 0x18c00, 0x4446ccdd, 0x54644
.long 0x97d000, 0x1cf100, 0x20000, 0x1ad00, 0x410000, 0x19d00, 0x4446ccdd, 0x54644
.long 0x97d000, 0x1cf100, 0x40000, 0x1ce00, 0x410000, 0x1ae00, 0x4446ccdd, 0x54644
.long 0x97d000, 0x1cf100, 0x60000, 0x1ef00, 0x410000, 0x1bf00, 0x4446ccdd, 0x54644
.long 0x97d000, 0x1cf100, 0x80000, 0x21000, 0x410000, 0x1d000, 0x4446ccdd, 0x54644
.long 0x97d000, 0x1cf100, 0xa0000, 0x23100, 0x410000, 0x1e100, 0x4446ccdd, 0x54644
.long 0x97d000, 0x1cf100, 0xc0000, 0x25200, 0x410000, 0x1f200, 0x4446ccdd, 0x54644
.long 0x0, 0x0, 0x0, 0x0, 0x1f, 0x0, 0x0, 0x0
.long 0x0, 0x0, 0x0, 0x0, 0x1f, 0x0, 0x0, 0x0
.long 0x0, 0x0, 0x0, 0x0, 0x1f, 0x0, 0x0, 0x0
.long 0x0, 0x0, 0x0, 0x0, 0x1f, 0x0, 0x0, 0x0
.long 0x97d000, 0x1cf100, 0x1c0000, 0x0, 0x3bcb0f80, 0x0, 0x0, 0xbff9
.long 0x97d000, 0x1cf100, 0xe0000, 0x18c00, 0x410000, 0x18c00, 0x444644dd, 0x44644
.long 0x97d000, 0x1cf100, 0x100000, 0x1ad00, 0x410000, 0x19d00, 0x444644dd, 0x44644
.long 0x97d000, 0x1cf100, 0x120000, 0x1ce00, 0x411000, 0x1ae00, 0x444644dd, 0x44644
.long 0x97d000, 0x1cf100, 0x140000, 0x1ef00, 0x411000, 0x1bf00, 0x444644dd, 0x44644
.long 0x97d000, 0x1cf100, 0x160000, 0x21000, 0x411000, 0x1d000, 0x444644dd, 0x44644
.long 0x97d000, 0x1cf100, 0x180000, 0x23100, 0x411000, 0x1e100, 0x444644dd, 0x44644
.long 0x97d000, 0x1cf100, 0x1a0000, 0x25200, 0x411000, 0x1f200, 0x444644dd, 0x44644
.long 0x97d000, 0x1cf100, 0x1c0000, 0x10800, 0x411000, 0x20300, 0x444644dd, 0x44644
.long 0x97d000, 0x1cf100, 0x1c0000, 0x0, 0x3bcb0f9e, 0x0, 0x0, 0xbff9
.long 0x97d000, 0x1cf100, 0x1c0000, 0x0, 0x3bcb0f9e, 0x0, 0x0, 0xbff9
.long 0x97d000, 0x1cf100, 0x1c0000, 0x0, 0x3bcb0f9e, 0x0, 0x0, 0xbff9
.long 0xba1000, 0x79100, 0x60000, 0x0, 0xfe0ba0, 0x1dab025, 0x0, 0xfff
.long 0xba1000, 0x79100, 0x0, 0x18c00, 0x7681040, 0x18c00, 0x4c, 0x0
.long 0xba1000, 0x79100, 0x20000, 0x1ad00, 0x7681040, 0x19d00, 0x4c, 0x0
.long 0xba1000, 0x79100, 0x40000, 0x1ce00, 0x7681040, 0x1ae00, 0x4c, 0x0
.long 0xba1000, 0x79100, 0x60000, 0x1ef00, 0x7681040, 0x1bf00, 0x4c, 0x0
.long 0x1025000, 0xd4100, 0x0, 0x25200, 0x5400c3, 0x11d000, 0x44446, 0x0
.long 0x1025000, 0xd4100, 0x20000, 0x23100, 0x5400c3, 0x11e100, 0x44446, 0x0
.long 0x1025000, 0xd4100, 0x40000, 0x21000, 0x5400c3, 0x11f200, 0x44446, 0x0
.long 0x1025000, 0xd4100, 0x60000, 0x1ef00, 0x5400c3, 0x120300, 0x44446, 0x0
.long 0x1025000, 0xd4100, 0x80000, 0x1ce00, 0x5400c3, 0x121400, 0x44446, 0x0
.long 0x1025000, 0xd4100, 0xa0000, 0x1ad00, 0x5400c3, 0x122500, 0x44446, 0x0
.long 0x1025000, 0xd4100, 0xc0000, 0x18c00, 0x5400c3, 0x123600, 0x44446, 0x0
.long 0xc1b000, 0x1ed100, 0x1e0000, 0x55680000, 0x35431000, 0x0, 0x0, 0x1ffff
.long 0xc1b000, 0x1ed100, 0x100000, 0x18c00, 0x380000, 0x18c00, 0x444644cc, 0x444644
.long 0xc1b000, 0x1ed100, 0x120000, 0x1ad00, 0x380000, 0x19d00, 0x444644cc, 0x444644
.long 0xc1b000, 0x1ed100, 0x140000, 0x1ce00, 0x380000, 0x1ae00, 0x444644cc, 0x444644
.long 0xc1b000, 0x1ed100, 0x160000, 0x1ef00, 0x380000, 0x1bf00, 0x444644cc, 0x444644
.long 0xc1b000, 0x1ed100, 0x180000, 0x21000, 0x60390000, 0x1d000, 0x444644cc, 0x554644
.long 0xc1b000, 0x1ed100, 0x1a0000, 0x23100, 0x60390000, 0x1e100, 0x444644cc, 0x554644
.long 0xc1b000, 0x1ed100, 0x1c0000, 0x25200, 0x60391000, 0x1f200, 0x444644cc, 0x554644
.long 0xc1b000, 0x1ed100, 0x1e0000, 0x10800, 0x60391000, 0x20300, 0x444644cc, 0x554644
.long 0xc1b000, 0x1ed100, 0x1e0000, 0x55680000, 0x3543101e, 0x0, 0x0, 0x1ffff
.long 0xc1b000, 0x1ed100, 0x1e0000, 0x55680000, 0x3543101e, 0x0, 0x0, 0x1ffff
.long 0xc1b000, 0x1ed100, 0x1e0000, 0x55680000, 0x3543101e, 0x0, 0x0, 0x1ffff
.long 0xe6c000, 0x1b8100, 0x1a0000, 0xaaa80000, 0x55260e00, 0x0, 0x0, 0x7ffb
.long 0xe6c000, 0x1b8100, 0xc0000, 0x18c00, 0x641000, 0x18c00, 0x444644dc, 0x4644
.long 0xe6c000, 0x1b8100, 0xe0000, 0x1ad00, 0x641000, 0x19d00, 0x444644dc, 0x4644
.long 0xe6c000, 0x1b8100, 0x100000, 0x1ce00, 0x641000, 0x1ae00, 0x444644dc, 0x4644
.long 0xe6c000, 0x1b8100, 0x120000, 0x1ef00, 0x641000, 0x1bf00, 0x444644dc, 0x4644
.long 0xe6c000, 0x1b8100, 0x140000, 0x21000, 0x641000, 0x1d000, 0x444644dc, 0x4644
.long 0xe6c000, 0x1b8100, 0x160000, 0x23100, 0x641000, 0x1e100, 0x444644dc, 0x4644
.long 0xe6c000, 0x1b8100, 0x180000, 0x25200, 0x641000, 0x1f200, 0x444644dc, 0x4644
.long 0xe6c000, 0x1b8100, 0x1a0000, 0x10800, 0x641000, 0x20300, 0x444644dc, 0x4644
.long 0x0, 0x0, 0x0, 0x0, 0x1f, 0x0, 0x0, 0x0
.long 0x0, 0x0, 0x0, 0x0, 0x1f, 0x0, 0x0, 0x0
.long 0x0, 0x0, 0x0, 0x0, 0x1f, 0x0, 0x0, 0x0
.long 0x4bb000, 0x173100, 0x160000, 0x0, 0x55530ca0, 0x0, 0x0, 0x17f9
.long 0x4bb000, 0x173100, 0x0, 0x18c00, 0x515040, 0x18c00, 0x444644dd, 0x44
.long 0x4bb000, 0x173100, 0x20000, 0x1ad00, 0x515040, 0x19d00, 0x444644dd, 0x44
.long 0x4bb000, 0x173100, 0x40000, 0x1ce00, 0x515040, 0x1ae00, 0x444644dd, 0x44
.long 0x4bb000, 0x173100, 0x60000, 0x1ef00, 0x515040, 0x1bf00, 0x444644dd, 0x44
.long 0x4bb000, 0x173100, 0x80000, 0x21000, 0x515040, 0x1d000, 0x444644dd, 0x44
.long 0x4bb000, 0x173100, 0xa0000, 0x23100, 0x515040, 0x1e100, 0x444644dd, 0x44
.long 0x4bb000, 0x173100, 0xc0000, 0x25200, 0x515040, 0x1f200, 0x444644dd, 0x44
.long 0x4bb000, 0x173100, 0xe0000, 0x10800, 0x515040, 0x20300, 0x444644dd, 0x44
.long 0x4bb000, 0x173100, 0x160000, 0x0, 0x55530cbe, 0x0, 0x0, 0x17f9
.long 0x4bb000, 0x173100, 0x160000, 0x0, 0x55530cbe, 0x0, 0x0, 0x17f9
.long 0x4bb000, 0x173100, 0x160000, 0x0, 0x55530cbe, 0x0, 0x0, 0x17f9
.long 0x208000, 0x181100, 0x180000, 0x0, 0x54821100, 0x10ed0fa, 0x0, 0x25fff
.long 0x208000, 0x181100, 0x0, 0x18c00, 0x1081000, 0x18c00, 0x444644cc, 0x644
.long 0x208000, 0x181100, 0x20000, 0x1ad00, 0x1081000, 0x19d00, 0x444644cc, 0x644
.long 0x208000, 0x181100, 0x40000, 0x1ce00, 0x1081000, 0x1ae00, 0x444644cc, 0x644
.long 0x208000, 0x181100, 0x60000, 0x1ef00, 0x1081000, 0x1bf00, 0x444644cc, 0x644
.long 0x208000, 0x181100, 0x80000, 0x21000, 0x1081000, 0x1d000, 0x444644cc, 0x644
.long 0x10fa000, 0x75100, 0x0, 0x25200, 0x5982e6, 0x5e100, 0x54, 0x0
.long 0x10fa000, 0x75100, 0x20000, 0x23100, 0x598267, 0x5f200, 0x54, 0x0
.long 0x10fa000, 0x75100, 0x40000, 0x21000, 0x5981e8, 0x60300, 0x54, 0x0
.long 0x10fa000, 0x75100, 0x60000, 0x1ef00, 0x598169, 0x61400, 0x54, 0x0
.long 0x0, 0x0, 0x0, 0x0, 0x1f, 0x0, 0x0, 0x0
.long 0x0, 0x0, 0x0, 0x0, 0x1f, 0x0, 0x0, 0x0
.long 0x38a000, 0x130100, 0x120000, 0x0, 0x4fe0a80, 0x0, 0x0, 0x7ff
.long 0x38a000, 0x130100, 0x0, 0x18c00, 0x441000, 0x18c00, 0x444644cc, 0x0
.long 0x38a000, 0x130100, 0x20000, 0x1ad00, 0x441000, 0x19d00, 0x444644cc, 0x0
.long 0x38a000, 0x130100, 0x40000, 0x1ce00, 0x441000, 0x1ae00, 0x444644cc, 0x0
.long 0x38a000, 0x130100, 0x60000, 0x1ef00, 0x441000, 0x1bf00, 0x444644cc, 0x0
.long 0x38a000, 0x130100, 0x80000, 0x21000, 0x441000, 0x1d000, 0x444644cc, 0x0
.long 0x38a000, 0x130100, 0xa0000, 0x23100, 0x441000, 0x1e100, 0x444644cc, 0x0
.long 0x38a000, 0x130100, 0xc0000, 0x25200, 0x441000, 0x1f200, 0x444644cc, 0x0
.long 0x38a000, 0x130100, 0xe0000, 0x10800, 0x441000, 0x20300, 0x444644cc, 0x0
.long 0x38a000, 0x130100, 0x100000, 0x12900, 0xa0451000, 0x21400, 0x555744cc, 0x0
.long 0x38a000, 0x130100, 0x120000, 0x14a00, 0xa0451000, 0x22500, 0x555744cc, 0x0
.long 0x0, 0x0, 0x0, 0x0, 0x1f, 0x0, 0x0, 0x0
.long 0x208000, 0x181100, 0x180000, 0x0, 0xaa1080, 0xca8b4d, 0x0, 0x1bffb
.long 0x208000, 0x181100, 0xa0000, 0x18c00, 0x2080000, 0x18c00, 0x444eccdc, 0x644
.long 0x208000, 0x181100, 0xc0000, 0x1ad00, 0x2080000, 0x19d00, 0x444eccdc, 0x644
.long 0x208000, 0x181100, 0xe0000, 0x1ce00, 0x2080000, 0x1ae00, 0x444eccdc, 0x644
.long 0x208000, 0x181100, 0x100000, 0x1ef00, 0x2080000, 0x1bf00, 0x444eccdc, 0x644
.long 0x208000, 0x181100, 0x120000, 0x21000, 0x2081000, 0x1d000, 0x444eccdc, 0x644
.long 0x208000, 0x181100, 0x140000, 0x23100, 0x2081000, 0x1e100, 0x444eccdc, 0x644
.long 0x208000, 0x181100, 0x160000, 0x25200, 0x2081000, 0x1f200, 0x444eccdc, 0x644
.long 0x208000, 0x181100, 0x180000, 0x10800, 0x2081000, 0x20300, 0x444eccdc, 0x644
.long 0xb4d000, 0x53100, 0x0, 0x25200, 0x5000e9, 0x61400, 0x5, 0x0
.long 0xb4d000, 0x53100, 0x20000, 0x23100, 0x5000e9, 0x62500, 0x5, 0x0
.long 0xb4d000, 0x53100, 0x40000, 0x21000, 0x5000e9, 0x63600, 0x5, 0x0
.long 0x62f000, 0x148100, 0x140000, 0x0, 0x55520f00, 0x10c6e09, 0x0, 0xa7fd
.long 0x62f000, 0x148100, 0x0, 0x18c00, 0x1241000, 0x18c00, 0x4446cccd, 0x4
.long 0x62f000, 0x148100, 0x20000, 0x1ad00, 0x1241000, 0x19d00, 0x4446cccd, 0x4
.long 0x62f000, 0x148100, 0x40000, 0x1ce00, 0x1241000, 0x1ae00, 0x4446cccd, 0x4
.long 0x62f000, 0x148100, 0x60000, 0x1ef00, 0x1241000, 0x1bf00, 0x4446cccd, 0x4
.long 0x62f000, 0x148100, 0x80000, 0x21000, 0x1241000, 0x1d000, 0x4446cccd, 0x4
.long 0x62f000, 0x148100, 0xa0000, 0x23100, 0x1241000, 0x1e100, 0x4446cccd, 0x4
.long 0x62f000, 0x148100, 0xc0000, 0x25200, 0x1241000, 0x1f200, 0x4446cccd, 0x4
.long 0xe09000, 0x62100, 0x0, 0x25200, 0xda264, 0x160300, 0x45, 0x0
.long 0xe09000, 0x62100, 0x20000, 0x23100, 0xda1e5, 0x161400, 0x45, 0x0
.long 0xe09000, 0x62100, 0x40000, 0x21000, 0xda166, 0x162500, 0x45, 0x0
.long 0xe09000, 0x62100, 0x60000, 0x1ef00, 0xda0e7, 0x163600, 0x45, 0x0
.section .rodata,"a"
.p2align 6
.amdhsa_kernel standalone__varlen_attn_packed__ragged_kernel
  .amdhsa_next_free_vgpr 168
  .amdhsa_next_free_sgpr 102
  .amdhsa_accum_offset 168
  .amdhsa_group_segment_fixed_size 0
  .amdhsa_kernarg_size 56
  .amdhsa_user_sgpr_count 2
  .amdhsa_user_sgpr_kernarg_segment_ptr 1
  .amdhsa_system_sgpr_workgroup_id_x 1
.end_amdhsa_kernel
```
